```python
import torch

def _softmax(x, axis=-1):
    return torch.softmax(x, dim=axis)
def _gelu(x):
    return torch.nn.functional.gelu(x, approximate="tanh")
def _silu(x):
    return torch.nn.functional.silu(x)
def _sigmoid(x):
    return torch.sigmoid(x)
def _layernorm(x, axis=-1, eps=1e-5):
    m = x.mean(dim=axis, keepdim=True)
    v = x.var(dim=axis, keepdim=True, unbiased=False)
    return (x - m) / torch.sqrt(v + eps)
def _scatter_add(tgt, idx, src, axis=0):
    return tgt.clone().index_add_(axis, idx, src)
def _segment_sum(src, seg, n):
    out = torch.zeros((n,) + src.shape[1:], dtype=src.dtype)
    return out.index_add_(0, seg, src)
def _pad(x, pw):
    flat = tuple(v for pair in reversed(pw) for v in pair)
    return torch.nn.functional.pad(x, flat)

kernel_name = 'parallel_sum__spectral_fnet__geglu_ffn__prompt'

def setup_inputs():

    _w = (lambda a: (lambda t: t.to(torch.bfloat16) if t.is_floating_point() else t)(torch.as_tensor(a)))
    def _A_setup():
        B, S, D = 1, 2048, 640
        ns = torch.arange(S)[:, None] * torch.arange(S)[None, :]
        nd = torch.arange(D)[:, None] * torch.arange(D)[None, :]
        Ws_re = torch.cos(-2.0 * torch.pi * ns / S).to(float)
        Ws_im = torch.sin(-2.0 * torch.pi * ns / S).to(float)
        Wd_re = torch.cos(-2.0 * torch.pi * nd / D).to(float)
        Wd_im = torch.sin(-2.0 * torch.pi * nd / D).to(float)
        return {
            "x": _w((lambda *s: torch.randn(*s, dtype=torch.bfloat16) * 0.05)(B, S, D)),
            "dft_seq_re": _w(Ws_re),
            "dft_seq_im": _w(Ws_im),
            "dft_hid_re": _w(Wd_re),
            "dft_hid_im": _w(Wd_im),
        }
    _A_in = _A_setup()

    def _B_setup():
        B, S, D, F = 1, 2048, 640, 1728
        return {
            "x": _w((lambda *s: torch.randn(*s, dtype=torch.bfloat16) * 0.05)(B, S, D)),
            "w_gate": _w((lambda *s: torch.randn(*s, dtype=torch.bfloat16) * 0.2)(D, F)),
            "w_up": _w((lambda *s: torch.randn(*s, dtype=torch.bfloat16) * 0.2)(D, F)),
            "w_down": _w((lambda *s: torch.randn(*s, dtype=torch.bfloat16) * 0.2)(F, D)),
        }
    _B_in = _B_setup()

    return {
        "A_x": _A_in["x"],
        "A_dft_seq_re": _A_in["dft_seq_re"],
        "A_dft_seq_im": _A_in["dft_seq_im"],
        "A_dft_hid_re": _A_in["dft_hid_re"],
        "A_dft_hid_im": _A_in["dft_hid_im"],
        "B_x": _B_in["x"],
        "B_w_gate": _B_in["w_gate"],
        "B_w_up": _B_in["w_up"],
        "B_w_down": _B_in["w_down"],
    }

def reference(A_x, A_dft_seq_re, A_dft_seq_im, A_dft_hid_re, A_dft_hid_im, B_x, B_w_gate, B_w_up, B_w_down):
    def _A_ref(x, dft_seq_re, dft_seq_im, dft_hid_re, dft_hid_im):
        a = torch.einsum("bsd,ed->bse", x, dft_hid_re)
        b = torch.einsum("bsd,ed->bse", x, dft_hid_im)
        y = torch.einsum("ts,bse->bte", dft_seq_re, a) - torch.einsum("ts,bse->bte", dft_seq_im, b)
        return y

    def _B_ref(x, w_gate, w_up, w_down):
        return (_gelu(x @ w_gate) * (x @ w_up)) @ w_down

    x = A_x
    xn = _layernorm(x, axis=-1)
    return x + _A_ref(xn, A_dft_seq_re, A_dft_seq_im, A_dft_hid_re, A_dft_hid_im) + _B_ref(xn, B_w_gate, B_w_up, B_w_down)
```

```asm
; @launch grid=(256,1,1) block=(512,1,1) lds=159744
.amdgcn_target "amdgcn-amd-amdhsa--gfx950"
.text
.globl parallel_sum__spectral_fnet__geglu_ffn__prompt_kernel
.p2align 8
.type parallel_sum__spectral_fnet__geglu_ffn__prompt_kernel,@function
parallel_sum__spectral_fnet__geglu_ffn__prompt_kernel:
    s_cmp_ge_u32 s2, 256
    s_cbranch_scc1 K_end
    s_load_dwordx2 s[4:5], s[0:1], 0
    s_load_dwordx4 s[40:43], s[0:1], 24
    s_load_dwordx4 s[44:47], s[0:1], 48
    s_load_dwordx4 s[48:51], s[0:1], 64
    s_load_dwordx4 s[64:67], s[0:1], 80
    s_memrealtime s[72:73]
    v_lshrrev_b32 v196, 6, v0
    v_and_b32 v1, 63, v0
    v_lshlrev_b32 v2, 4, v1
    v_readfirstlane_b32 s28, v196
    s_and_b32 s52, s2, 7
    s_lshr_b32 s53, s2, 3
    s_and_b32 s29, s52, 4
    s_lshr_b32 s54, s53, 3
    s_add_u32 s29, s29, s54
    s_and_b32 s30, s52, 3
    s_lshl_b32 s30, s30, 3
    s_and_b32 s54, s53, 7
    s_add_u32 s30, s30, s54
    s_lshr_b32 s55, s28, 1
    s_and_b32 s56, s28, 1
    s_lshr_b32 s32, s29, 2
    s_add_u32 s32, s32, s29
    s_movk_i32 s58, 3456
    s_cmp_ge_u32 s30, 27
    s_cselect_b32 s31, 1, 0
    s_cselect_b32 s58, 1280, s58
    s_cselect_b32 s54, 27, 0
    s_sub_u32 s59, s30, s54
    s_lshl_b32 s35, s58, 6
    s_lshl_b32 s36, s28, 12
    s_lshl_b32 s37, s28, 10
    s_add_u32 s37, s37, 32768
    v_lshrrev_b32 v196, 3, v1
    v_and_b32 v198, 7, v1
    v_lshrrev_b32 v199, 4, v1
    v_lshrrev_b32 v220, 3, v1
    v_xor_b32 v200, v198, v199
    s_lshl_b32 s54, s28, 3
    v_add_u32 v196, s54, v196
    v_mul_u32_u24 v202, s58, v196
    v_mov_b32 v227, v196
    v_and_b32 v199, 1, v199
    v_lshlrev_b32 v199, 1, v199
    s_lshl_b32 s54, s56, 2
    v_or_b32 v199, s54, v199
    v_xor_b32 v199, v198, v199
    v_lshl_add_u32 v24, v199, 4, v202
    s_lshl_b32 s54, s59, 7
    v_add_u32 v24, s54, v24
    s_mul_i32 s14, s58, 640
    s_mov_b32 s15, 0x00020000
    s_mov_b32 s18, s14
    s_mov_b32 s19, 0x00020000
    s_mov_b32 s10, 2621440
    s_mov_b32 s11, 0x00020000
    s_cmp_eq_u32 s31, 1
    s_waitcnt lgkmcnt(0)
    s_mov_b32 s8, s4
    s_mov_b32 s9, s5
    s_cselect_b64 s[12:13], s[40:41], s[44:45]
    s_cselect_b64 s[16:17], s[42:43], s[46:47]
    s_lshl_b32 s33, s32, 7
    s_mul_i32 s34, s32, s35
    s_add_u32 s32, s32, 1
    s_cmp_eq_u32 s32, 10
    s_cselect_b32 s32, 0, s32
    s_add_u32 m0, s37, 0
    s_nop 0
    buffer_load_dwordx4 v24, s[12:15], s34 offen lds
    s_add_u32 m0, s37, 8192
    s_nop 0
    buffer_load_dwordx4 v24, s[16:19], s34 offen lds
    s_lshl_b32 s57, s29, 1
    s_lshr_b32 s54, s55, 1
    s_add_u32 s57, s57, s54
    s_sub_u32 s54, 32, s57
    s_cmp_eq_u32 s57, 0
    s_cselect_b32 s54, 16, s54
    s_bitcmp1_b32 s55, 0
    s_cselect_b32 s57, s54, s57
    v_lshlrev_b32 v197, 6, v220
    s_lshl_b32 s54, s56, 5
    s_add_u32 s54, s54, s57
    v_add_u32 v197, s54, v197
    v_mul_u32_u24 v197, 1280, v197
    v_xor_b32 v201, 4, v200
    v_lshl_add_u32 v200, v200, 4, v197
    v_lshl_add_u32 v201, v201, 4, v197
    v_add_u32 v201, 655360, v201
    s_and_b32 s54, s30, 1
    s_lshl_b32 s63, s54, 11
    s_mul_i32 s54, s54, 1310720
    v_add_u32 v20, s54, v200
    v_add_u32 v21, s54, v201
    s_sub_u32 s54, 1310720, s54
    v_add_u32 v22, s54, v200
    v_add_u32 v23, s54, v201
    s_sub_u32 s3, s36, s63
    s_add_u32 s36, s36, s63
    s_cmp_lt_u32 s28, 4
    s_cbranch_scc1 K_nomt
    s_and_b32 s54, s55, 1
    s_mul_i32 s54, s54, 320
    s_lshl_b32 s61, s29, 3
    s_add_u32 s54, s54, s61
    s_lshl_b32 s61, s28, 3
    s_sub_u32 s54, s54, s61
    s_add_u32 s54, s54, 256
    s_mul_i32 s54, s54, s58
    s_cmp_eq_u32 s56, 0
    s_cbranch_scc1 K_mt0
    buffer_load_dwordx4 v[232:235], v24, s[16:19], s54 offen
    s_branch K_nomt
K_mt0:
    buffer_load_dwordx4 v[232:235], v24, s[12:15], s54 offen
K_nomt:
    s_add_u32 m0, s36, 0
    s_nop 0
    buffer_load_dwordx4 v20, s[8:11], s33 offen lds
    s_add_u32 m0, s36, 1024
    s_nop 0
    buffer_load_dwordx4 v21, s[8:11], s33 offen lds
    s_add_u32 m0, s3, 2048
    s_nop 0
    buffer_load_dwordx4 v22, s[8:11], s33 offen lds
    s_add_u32 m0, s3, 3072
    s_nop 0
    buffer_load_dwordx4 v23, s[8:11], s33 offen lds
    s_lshr_b32 s61, s30, 3
    s_lshl_b32 s60, s29, 1
    s_lshr_b32 s54, s61, 1
    s_add_u32 s60, s60, s54
    s_sub_u32 s54, 32, s60
    s_cmp_eq_u32 s60, 0
    s_cselect_b32 s54, 16, s54
    s_bitcmp1_b32 s61, 0
    s_cselect_b32 s60, s54, s60
    s_lshl_b32 s62, s30, 3
    s_add_u32 s62, s62, s28
    s_and_b32 s54, s62, 32
    s_add_u32 s60, s60, s54
    s_and_b32 s54, s62, 31
    s_lshl_b32 s54, s54, 6
    s_add_u32 s60, s60, s54
    s_mul_i32 s60, s60, 1280
    v_lshlrev_b32 v204, 2, v1
    s_getpc_b64 s[74:75]
K_pc:
    s_and_b32 s54, s53, 7
    s_mul_i32 s54, s54, 5120
    v_lshl_add_u32 v216, v1, 7, s54
    v_min_u32 v216, K_end - K_pc, v216
    s_cmp_eq_u32 s28, 7
    s_cbranch_scc0 K_noipf
    global_load_dword v217, v216, s[74:75]
K_noipf:
    s_mov_b32 s76, s64
    s_mov_b32 s77, s65
    s_mov_b32 s78, 256
    s_mov_b32 s79, 0x00020000
    v_mov_b32 v203, 0
    v_mov_b32 v31, 2146435072
    v_cmp_eq_u32 vcc, 0, v0
    s_or_b32 s72, s72, 1
    v_mov_b32 v6, s72
    v_cndmask_b32 v31, v31, v203, vcc
    v_mov_b32 v7, s73
    s_cmp_eq_u32 s2, 0
    s_cbranch_scc0 K_nonon
    buffer_store_dwordx2 v[6:7], v31, s[76:79], 0 offen sc1
K_nonon:
    v_and_b32 v212, 15, v1
    v_lshrrev_b32 v213, 4, v1
    v_lshrrev_b32 v199, 1, v212
    v_xor_b32 v199, v199, v213
    v_bfe_u32 v200, v1, 2, 2
    v_lshl_add_u32 v201, v213, 3, v200
    v_lshlrev_b32 v201, 7, v201
    v_bfe_u32 v202, v1, 3, 1
    v_bfe_u32 v214, v1, 4, 1
    v_lshl_add_u32 v202, v214, 1, v202
    v_and_b32 v214, 3, v1
    v_lshl_add_u32 v201, v214, 3, v201
    s_and_b32 s61, s55, 1
    s_lshl_b32 s63, s55, 13
    s_lshl_b32 s38, s56, 1
    s_lshr_b32 s39, s28, 2
    s_lshl_b32 s54, s39, 14
    s_and_b32 s44, s28, 3
    s_cmp_eq_u32 s31, 1
    s_cselect_b32 s61, s39, s61
    s_cselect_b32 s63, s54, s63
    s_cselect_b32 s38, s44, s38
    s_lshl_b32 s54, s61, 2
    v_xor_b32 v199, s54, v199
    v_lshl_add_u32 v215, v212, 7, s63
    v_lshl_add_u32 v8, v199, 4, v215
    v_xor_b32 v9, 64, v8
    v_add_u32 v10, 98304, v8
    v_add_u32 v11, 98304, v9
    v_xor_b32 v202, s38, v202
    v_lshl_add_u32 v201, v202, 5, v201
    s_lshl_b32 s54, s61, 12
    s_add_u32 s54, s54, 32768
    v_add_u32 v12, s54, v201
    v_xor_b32 v13, 32, v12
    v_xor_b32 v14, 4096, v12
    v_xor_b32 v15, 4096, v13
    v_add_u32 v16, 98304, v12
    v_add_u32 v17, 98304, v13
    v_add_u32 v18, 98304, v14
    v_add_u32 v19, 98304, v15
    s_mov_b32 s20, s66
    s_mov_b32 s21, s67
    s_mov_b32 s22, 16777216
    s_mov_b32 s23, 0x00020000
    s_cmp_eq_u32 s31, 1
    s_cbranch_scc1 K_dftpro
    v_bfe_u32 v215, v1, 3, 2
    v_lshl_add_u32 v201, v213, 2, v200
    s_add_u32 s61, s28, 0
    s_cmp_ge_u32 s61, 5
    s_cselect_b32 s63, 1, 0
    s_mul_i32 s54, s63, 5
    s_sub_u32 s61, s61, s54
    v_xor_b32 v220, s61, v215
    v_lshlrev_b32 v220, 5, v220
    s_mov_b32 s38, 147456
    s_cmp_eq_u32 s61, 4
    s_cselect_b32 s38, 155648, s38
    s_cselect_b32 s39, 5, 7
    s_cselect_b64 vcc, -1, 0
    s_lshl_b32 s54, s63, 5
    v_add_u32 v202, s54, v201
    v_lshlrev_b32 v202, s39, v202
    v_lshl_add_u32 v202, v214, 3, v202
    v_cndmask_b32 v220, v220, 0, vcc
    v_add3_u32 v26, s38, v202, v220
    s_lshl_b32 s54, 16, s39
    v_add_u32 v27, s54, v26
    s_mul_i32 s54, s29, 54
    s_add_u32 s54, s54, s63
    s_lshl_b32 s63, s30, 1
    s_add_u32 s54, s54, s63
    s_mul_i32 s54, s54, 5
    s_add_u32 s54, s54, s61
    s_lshl_b32 s54, s54, 10
    s_add_u32 s46, s54, 8388608
    s_add_u32 s61, s28, 8
    s_cmp_ge_u32 s61, 5
    s_cselect_b32 s63, 1, 0
    s_mul_i32 s54, s63, 5
    s_sub_u32 s61, s61, s54
    v_xor_b32 v220, s61, v215
    v_lshlrev_b32 v220, 5, v220
    s_mov_b32 s38, 147456
    s_cmp_eq_u32 s61, 4
    s_cselect_b32 s38, 155648, s38
    s_cselect_b32 s39, 5, 7
    s_cselect_b64 vcc, -1, 0
    s_lshl_b32 s54, s63, 5
    v_add_u32 v202, s54, v201
    v_lshlrev_b32 v202, s39, v202
    v_lshl_add_u32 v202, v214, 3, v202
    v_cndmask_b32 v220, v220, 0, vcc
    v_add3_u32 v28, s38, v202, v220
    s_lshl_b32 s54, 16, s39
    v_add_u32 v29, s54, v28
    s_mul_i32 s54, s29, 54
    s_add_u32 s54, s54, s63
    s_lshl_b32 s63, s30, 1
    s_add_u32 s54, s54, s63
    s_mul_i32 s54, s54, 5
    s_add_u32 s54, s54, s61
    s_lshl_b32 s54, s54, 10
    s_add_u32 s47, s54, 8388608
    v_mov_b32 v228, 0x3f803f80
    v_mov_b32 v229, 0x3f803f80
    v_mov_b32 v230, 0x3f803f80
    v_mov_b32 v231, 0x3f803f80
    s_branch K_pro2
K_dftpro:
    s_and_b32 s54, s55, 1
    s_lshl_b32 s54, s54, 4
    v_add_u32 v196, s54, v212
    v_lshl_add_u32 v199, v213, 3, s56
    v_mul_u32_u24 v199, v199, v196
    s_mov_b32 s54, 1015021568
    s_mov_b32 s61, 0
    s_cmp_ge_u32 s55, 2
    s_cselect_b32 s61, 3196059648, s61
    v_mov_b32 v25, 0xbf803f80
    v_mad_u32_u24 v218, v196, 0, v199
    v_and_b32 v218, 63, v218
    v_cvt_f32_u32 v218, v218
    v_mul_f32 v218, s54, v218
    v_add_f32 v218, s61, v218
    v_cos_f32 v218, v218
    v_mad_u32_u24 v219, v196, 2, v199
    v_and_b32 v219, 63, v219
    v_cvt_f32_u32 v219, v219
    v_mul_f32 v219, s54, v219
    v_add_f32 v219, s61, v219
    v_cos_f32 v219, v219
    v_mad_u32_u24 v220, v196, 4, v199
    v_and_b32 v220, 63, v220
    v_cvt_f32_u32 v220, v220
    v_mul_f32 v220, s54, v220
    v_add_f32 v220, s61, v220
    v_cos_f32 v220, v220
    v_mad_u32_u24 v221, v196, 6, v199
    v_and_b32 v221, 63, v221
    v_cvt_f32_u32 v221, v221
    v_mul_f32 v221, s54, v221
    v_add_f32 v221, s61, v221
    v_cos_f32 v221, v221
    v_mad_u32_u24 v222, v196, 32, v199
    v_and_b32 v222, 63, v222
    v_cvt_f32_u32 v222, v222
    v_mul_f32 v222, s54, v222
    v_add_f32 v222, s61, v222
    v_cos_f32 v222, v222
    v_mad_u32_u24 v223, v196, 34, v199
    v_and_b32 v223, 63, v223
    v_cvt_f32_u32 v223, v223
    v_mul_f32 v223, s54, v223
    v_add_f32 v223, s61, v223
    v_cos_f32 v223, v223
    v_mad_u32_u24 v224, v196, 36, v199
    v_and_b32 v224, 63, v224
    v_cvt_f32_u32 v224, v224
    v_mul_f32 v224, s54, v224
    v_add_f32 v224, s61, v224
    v_cos_f32 v224, v224
    v_mad_u32_u24 v225, v196, 38, v199
    v_and_b32 v225, 63, v225
    v_cvt_f32_u32 v225, v225
    v_mul_f32 v225, s54, v225
    v_add_f32 v225, s61, v225
    v_cos_f32 v225, v225
    s_mov_b32 s54, 0x3f803f80
    s_cmp_eq_u32 s56, 1
    s_cselect_b32 s54, 0xbf80bf80, s54
    v_mov_b32 v226, s54
    s_cmp_eq_u32 s55, 2
    s_cselect_b32 s44, 0x00010001, 0
    s_mov_b32 s45, s44
    s_cmp_eq_u32 s30, 27
    s_cselect_b32 s70, 0x00010001, 0
    s_and_b32 s54, s28, 3
    s_cmp_eq_u32 s54, 0
    s_cselect_b32 s70, s70, 0
    s_mov_b32 s71, s70
    v_cvt_pk_bf16_f32 v228, v218, v219
    v_cvt_pk_bf16_f32 v229, v220, v221
    v_cvt_pk_bf16_f32 v230, v222, v223
    v_cvt_pk_bf16_f32 v231, v224, v225
    v_cndmask_b32 v228, v228, v226, s[44:45]
    v_cndmask_b32 v229, v229, v226, s[44:45]
    v_cndmask_b32 v230, v230, v226, s[44:45]
    v_cndmask_b32 v231, v231, v226, s[44:45]
    s_lshl_b32 s54, s28, 10
    s_add_u32 s54, s54, 147456
    v_add_u32 v226, s54, v2
    ds_write_b128 v226, v[228:231]
K_pro2:
    buffer_load_dwordx4 v[206:209], v2, s[8:11], s60 offen
    buffer_load_dword v210, v204, s[8:11], s60 offen offset:1024
    s_mov_b32 s24, s48
    s_mov_b32 s25, s49
    s_mov_b32 s26, 2211840
    s_mov_b32 s27, 0x00020000
    s_cmp_eq_u32 s31, 1
    s_cbranch_scc1 K_nortf
    s_lshl_b32 s54, s30, 6
    v_add_u32 v205, s54, v227
    v_mul_u32_u24 v205, 1280, v205
    v_lshrrev_b32 v204, 4, v1
    v_lshlrev_b32 v204, 1, v204
    v_and_b32 v197, 7, v1
    v_xor_b32 v204, v204, v197
    v_lshl_add_u32 v204, v204, 4, v205
    v_lshl_add_u32 v205, v197, 2, v205
    s_mul_i32 s61, s29, 160
    s_add_u32 m0, s37, 114688
    s_lshl_b32 s54, s28, 8
    buffer_load_dwordx4 v204, s[24:27], s61 offen lds
    s_add_u32 m0, s54, 155520
    s_nop 0
    buffer_load_dword v205, s[24:27], s61 offen offset:128 lds
K_nortf:
    s_lshl_b32 s33, s32, 7
    s_mul_i32 s34, s32, s35
    s_add_u32 s32, s32, 1
    s_cmp_eq_u32 s32, 10
    s_cselect_b32 s32, 0, s32
    s_add_u32 m0, s36, 49152
    s_nop 0
    buffer_load_dwordx4 v20, s[8:11], s33 offen lds
    s_add_u32 m0, s36, 50176
    s_nop 0
    buffer_load_dwordx4 v21, s[8:11], s33 offen lds
    s_add_u32 m0, s3, 51200
    s_nop 0
    buffer_load_dwordx4 v22, s[8:11], s33 offen lds
    s_add_u32 m0, s3, 52224
    s_nop 0
    buffer_load_dwordx4 v23, s[8:11], s33 offen lds
    s_lshr_b32 s54, s53, 3
    s_lshl_b32 s40, s52, 1
    s_sub_u32 s41, 32, s40
    s_cmp_eq_u32 s52, 0
    s_cselect_b32 s41, 16, s41
    s_add_u32 s42, s40, 1
    s_sub_u32 s43, 31, s40
    s_cmp_eq_u32 s54, 1
    s_cselect_b32 s40, s42, s40
    s_cmp_eq_u32 s54, 2
    s_cselect_b32 s40, s41, s40
    s_cmp_eq_u32 s54, 3
    s_cselect_b32 s40, s43, s40
    s_and_b32 s41, s53, 7
    s_sub_u32 s45, 64, s40
    s_cmp_eq_u32 s40, 0
    s_cselect_b32 s45, 32, s45
    s_cmp_ge_u32 s41, 4
    s_cselect_b32 s61, 3212836864, 1065353216
    s_xor_b32 s63, s61, 0x80000000
    s_cmp_eq_u32 s56, 0
    s_cselect_b32 s44, s40, s45
    s_cselect_b32 s80, 3212836864, 1065353216
    s_cselect_b32 s81, s61, s63
    s_cselect_b32 s82, 1065353216, 0
    s_cselect_b32 s83, 0, 1065353216
    s_cselect_b32 s38, s61, 0
    s_cselect_b32 s39, 0, s61
    s_cmp_eq_u32 s40, 0
    s_cselect_b32 s82, s82, 1065353216
    s_cselect_b32 s83, s83, 0
    s_cselect_b32 s80, 0, s80
    s_cselect_b32 s38, s38, s61
    s_cselect_b32 s81, 0, s81
    s_cselect_b32 s39, s39, 0
    s_lshl_b32 s54, s55, 2
    v_add_u32 v240, s54, v213
    v_sub_u32 v241, 32, v240
    v_cmp_eq_u32 vcc, 0, v240
    v_lshl_add_u32 v242, v212, 6, s44
    s_mov_b32 s54, 973078528
    v_cndmask_b32 v241, v241, 16, vcc
    v_add_u32 v243, 1024, v242
    v_mul_u32_u24 v244, v242, v240
    v_and_b32 v244, 2047, v244
    v_cvt_f32_u32 v244, v244
    v_mul_f32 v244, s54, v244
    v_mul_u32_u24 v245, v242, v241
    v_and_b32 v245, 2047, v245
    v_cvt_f32_u32 v245, v245
    v_mul_f32 v245, s54, v245
    v_mul_u32_u24 v246, v243, v240
    v_and_b32 v246, 2047, v246
    v_cvt_f32_u32 v246, v246
    v_mul_f32 v246, s54, v246
    v_mul_u32_u24 v247, v243, v241
    v_and_b32 v247, 2047, v247
    v_cvt_f32_u32 v247, v247
    v_mul_f32 v247, s54, v247
    v_cos_f32 v248, v244
    v_sin_f32 v244, v244
    v_cos_f32 v249, v245
    v_sin_f32 v245, v245
    v_cos_f32 v250, v246
    v_sin_f32 v246, v246
    v_cos_f32 v251, v247
    v_sin_f32 v247, v247
    v_mul_f32 v236, s82, v248
    v_mul_f32 v237, s83, v248
    v_mul_f32 v238, s38, v244
    v_mul_f32 v239, s81, v248
    v_fma_f32 v237, s80, v244, v237
    v_fma_f32 v239, s39, v244, v239
    v_cvt_pk_bf16_f32 v104, v236, v237
    v_cvt_pk_bf16_f32 v105, v238, v239
    v_mul_f32 v236, s82, v249
    v_mul_f32 v237, s83, v249
    v_mul_f32 v238, s38, v245
    v_mul_f32 v239, s81, v249
    v_fma_f32 v237, s80, v245, v237
    v_fma_f32 v239, s39, v245, v239
    v_cvt_pk_bf16_f32 v106, v236, v237
    v_cvt_pk_bf16_f32 v107, v238, v239
    v_mul_f32 v236, s82, v250
    v_mul_f32 v237, s83, v250
    v_mul_f32 v238, s38, v246
    v_mul_f32 v239, s81, v250
    v_fma_f32 v237, s80, v246, v237
    v_fma_f32 v239, s39, v246, v239
    v_cvt_pk_bf16_f32 v108, v236, v237
    v_cvt_pk_bf16_f32 v109, v238, v239
    v_mul_f32 v236, s82, v251
    v_mul_f32 v237, s83, v251
    v_mul_f32 v238, s38, v247
    v_mul_f32 v239, s81, v251
    v_fma_f32 v237, s80, v247, v237
    v_fma_f32 v239, s39, v247, v239
    v_cvt_pk_bf16_f32 v110, v236, v237
    v_cvt_pk_bf16_f32 v111, v238, v239
    s_waitcnt vmcnt(6) lgkmcnt(0)
    s_barrier
    s_cmp_eq_u32 s31, 1
    s_cbranch_scc1 K_loopD
    ds_read_b64_tr_b16 v[148:149], v12 offset:0
    ds_read_b64_tr_b16 v[150:151], v12 offset:512
    ds_read_b64_tr_b16 v[152:153], v13 offset:0
    ds_read_b64_tr_b16 v[154:155], v13 offset:512
    ds_read_b64_tr_b16 v[156:157], v12 offset:8192
    ds_read_b64_tr_b16 v[158:159], v12 offset:8704
    ds_read_b64_tr_b16 v[160:161], v13 offset:8192
    ds_read_b64_tr_b16 v[162:163], v13 offset:8704
    ds_read_b128 v[132:135], v8 offset:0
    ds_read_b128 v[136:139], v8 offset:2048
    ds_read_b128 v[140:143], v8 offset:4096
    ds_read_b128 v[144:147], v8 offset:6144
    s_waitcnt lgkmcnt(0)
    s_add_u32 m0, s37, 49152
    v_mfma_f32_16x16x32_bf16 v[32:35], v[148:151], v[132:135], 0
    ds_read_b64_tr_b16 v[180:181], v14 offset:0
    buffer_load_dwordx4 v24, s[12:15], s34 offen lds
    s_mul_i32 s42, s28, 7
    s_cmp_eq_u32 s28, 7
    s_cselect_b32 s42, 48, s42
    s_mul_i32 s43, s41, 54
    v_mfma_f32_16x16x32_bf16 v[48:51], v[148:151], v[136:139], 0
    ds_read_b64_tr_b16 v[182:183], v14 offset:512
    s_add_u32 s43, s43, s42
    s_mul_i32 s43, s43, 5120
    s_add_u32 m0, s37, 57344
    v_mfma_f32_16x16x32_bf16 v[64:67], v[148:151], v[140:143], 0
    ds_read_b64_tr_b16 v[184:185], v15 offset:0
    buffer_load_dwordx4 v24, s[16:19], s34 offen lds
    s_add_u32 s43, s43, 8388608
    s_mul_i32 s54, s40, 54
    s_add_u32 s42, s42, s54
    v_mfma_f32_16x16x32_bf16 v[80:83], v[148:151], v[144:147], 0
    ds_read_b64_tr_b16 v[186:187], v15 offset:512
    s_lshl_b32 s42, s42, 12
    s_lshr_b32 s54, s29, 2
    v_mfma_f32_16x16x32_bf16 v[84:87], v[152:155], v[144:147], 0
    ds_read_b64_tr_b16 v[188:189], v14 offset:8192
    s_add_u32 s54, s54, s29
    s_lshr_b32 s61, s55, 1
    s_add_u32 s54, s54, s61
    s_lshl_b32 s33, s32, 7
    s_mul_i32 s34, s32, s35
    s_add_u32 s32, s32, 1
    s_cmp_eq_u32 s32, 10
    s_cselect_b32 s32, 0, s32
    s_add_u32 m0, s36, 98304
    v_mfma_f32_16x16x32_bf16 v[68:71], v[152:155], v[140:143], 0
    ds_read_b64_tr_b16 v[190:191], v14 offset:8704
    buffer_load_dwordx4 v20, s[8:11], s33 offen lds
    s_lshl_b32 s54, s54, 1
    s_and_b32 s61, s55, 1
    v_mfma_f32_16x16x32_bf16 v[52:55], v[152:155], v[136:139], 0
    ds_read_b64_tr_b16 v[192:193], v15 offset:8192
    s_add_u32 s54, s54, s61
    s_mul_i32 s61, s30, 20
    s_add_u32 s54, s54, s61
    s_add_u32 m0, s36, 99328
    v_mfma_f32_16x16x32_bf16 v[36:39], v[152:155], v[132:135], 0
    ds_read_b64_tr_b16 v[194:195], v15 offset:8704
    buffer_load_dwordx4 v21, s[8:11], s33 offen lds
    s_lshl_b32 s54, s54, 9
    s_lshl_b32 s61, s56, 8
    v_mfma_f32_16x16x32_bf16 v[44:47], v[160:163], v[132:135], 0
    ds_read_b128 v[164:167], v9 offset:0
    s_add_u32 s54, s54, s61
    s_add_u32 s69, s54, 15990784
    s_and_b32 s54, s29, 3
    v_mfma_f32_16x16x32_bf16 v[60:63], v[160:163], v[136:139], 0
    ds_read_b128 v[168:171], v9 offset:2048
    s_cmp_eq_u32 s54, 3
    s_cselect_b32 s49, 1, 0
    s_cmp_ge_u32 s55, 2
    s_cselect_b32 s74, s49, 0
    s_cselect_b32 s49, s49, 1
    s_add_u32 m0, s3, 100352
    v_mfma_f32_16x16x32_bf16 v[76:79], v[160:163], v[140:143], 0
    ds_read_b128 v[172:175], v9 offset:4096
    buffer_load_dwordx4 v22, s[8:11], s33 offen lds
    s_lshl_b32 s68, s29, 5
    s_add_u32 s68, s68, s30
    s_lshl_b32 s38, s68, 3
    v_mfma_f32_16x16x32_bf16 v[92:95], v[160:163], v[144:147], 0
    ds_read_b128 v[176:179], v9 offset:6144
    s_add_u32 s48, s38, 15794176
    s_lshl_b32 s68, s68, 8
    s_add_u32 m0, s3, 101376
    v_mfma_f32_16x16x32_bf16 v[88:91], v[156:159], v[144:147], 0
    buffer_load_dwordx4 v23, s[8:11], s33 offen lds
    s_add_u32 s68, s68, 15798272
    s_lshl_b32 s54, s29, 12
    s_lshl_b32 s61, s62, 4
    v_mfma_f32_16x16x32_bf16 v[72:75], v[156:159], v[140:143], 0
    s_add_u32 s54, s54, s61
    s_add_u32 s38, s54, 15761408
    v_mfma_f32_16x16x32_bf16 v[56:59], v[156:159], v[136:139], 0
    v_cmp_eq_u32 vcc, 0, v1
    v_mov_b32 v254, 2146435072
    v_mov_b32 v255, 986500301
    v_cndmask_b32 v254, v254, 0, vcc
    v_mfma_f32_16x16x32_bf16 v[40:43], v[156:159], v[132:135], 0
    v_add_u32 v3, 4096, v2
    v_mov_b32 v4, 0
    v_lshlrev_b32 v30, 2, v1
    v_mov_b32 v5, 0
    s_bitcmp1_b32 s55, 1
    s_cbranch_scc1 K_ncs0
    v_mfma_f32_16x16x32_bf16 v[212:215], v[228:231], v[148:151], 0
    v_mfma_f32_16x16x32_bf16 v[216:219], v[228:231], v[152:155], 0
    v_mfma_f32_16x16x32_bf16 v[220:223], v[228:231], v[156:159], 0
    v_mfma_f32_16x16x32_bf16 v[224:227], v[228:231], v[160:163], 0
K_ncs0:
    s_waitcnt lgkmcnt(0)
    s_add_u32 m0, s37, 98304
    v_mfma_f32_16x16x32_bf16 v[32:35], v[180:183], v[164:167], v[32:35]
    buffer_load_dwordx4 v24, s[12:15], s34 offen lds
    v_mfma_f32_16x16x32_bf16 v[48:51], v[180:183], v[168:171], v[48:51]
    v_mfma_f32_16x16x32_bf16 v[64:67], v[180:183], v[172:175], v[64:67]
    s_add_u32 m0, s37, 106496
    s_nop 0
    buffer_load_dwordx4 v24, s[16:19], s34 offen lds
    s_waitcnt vmcnt(6)
    s_barrier
    ds_read_b64_tr_b16 v[148:149], v12 offset:49152
    v_mfma_f32_16x16x32_bf16 v[80:83], v[180:183], v[176:179], v[80:83]
    ds_read_b64_tr_b16 v[150:151], v12 offset:49664
    v_mfma_f32_16x16x32_bf16 v[84:87], v[184:187], v[176:179], v[84:87]
    ds_read_b64_tr_b16 v[152:153], v13 offset:49152
    v_lshlrev_b32 v236, 16, v206
    v_and_b32 v237, 0xffff0000, v206
    v_mfma_f32_16x16x32_bf16 v[68:71], v[184:187], v[172:175], v[68:71]
    ds_read_b64_tr_b16 v[154:155], v13 offset:49664
    v_lshlrev_b32 v238, 16, v207
    v_and_b32 v239, 0xffff0000, v207
    v_mfma_f32_16x16x32_bf16 v[52:55], v[184:187], v[168:171], v[52:55]
    ds_read_b64_tr_b16 v[156:157], v12 offset:57344
    v_lshlrev_b32 v240, 16, v208
    v_and_b32 v241, 0xffff0000, v208
    v_mfma_f32_16x16x32_bf16 v[36:39], v[184:187], v[164:167], v[36:39]
    ds_read_b64_tr_b16 v[158:159], v12 offset:57856
    v_lshlrev_b32 v242, 16, v209
    v_and_b32 v243, 0xffff0000, v209
    v_mfma_f32_16x16x32_bf16 v[44:47], v[192:195], v[164:167], v[44:47]
    ds_read_b64_tr_b16 v[160:161], v13 offset:57344
    v_lshlrev_b32 v244, 16, v210
    v_and_b32 v245, 0xffff0000, v210
    v_mfma_f32_16x16x32_bf16 v[60:63], v[192:195], v[168:171], v[60:63]
    ds_read_b64_tr_b16 v[162:163], v13 offset:57856
    v_add_f32 v246, v236, v237
    v_add_f32 v247, v238, v239
    v_mfma_f32_16x16x32_bf16 v[76:79], v[192:195], v[172:175], v[76:79]
    ds_read_b128 v[132:135], v8 offset:49152
    ds_read_b64_tr_b16 v[196:197], v26
    v_add_f32 v246, v246, v240
    v_add_f32 v247, v247, v241
    s_lshl_b32 s33, s32, 7
    s_mul_i32 s34, s32, s35
    s_add_u32 s32, s32, 1
    s_cmp_eq_u32 s32, 10
    s_cselect_b32 s32, 0, s32
    s_add_u32 m0, s36, 0
    v_mfma_f32_16x16x32_bf16 v[92:95], v[192:195], v[176:179], v[92:95]
    ds_read_b128 v[136:139], v8 offset:51200
    buffer_load_dwordx4 v20, s[8:11], s33 offen lds
    ds_read_b64_tr_b16 v[198:199], v27
    v_add_f32 v246, v246, v242
    v_add_f32 v247, v247, v243
    v_mfma_f32_16x16x32_bf16 v[88:91], v[188:191], v[176:179], v[88:91]
    ds_read_b128 v[140:143], v8 offset:53248
    ds_read_b64_tr_b16 v[200:201], v28
    v_add_f32 v246, v246, v244
    v_add_f32 v247, v247, v245
    v_mfma_f32_16x16x32_bf16 v[72:75], v[188:191], v[172:175], v[72:75]
    ds_read_b128 v[144:147], v8 offset:55296
    ds_read_b64_tr_b16 v[202:203], v29
    v_add_f32 v246, v246, v247
    s_add_u32 m0, s36, 1024
    v_mfma_f32_16x16x32_bf16 v[56:59], v[188:191], v[168:171], v[56:59]
    buffer_load_dwordx4 v21, s[8:11], s33 offen lds
    s_nop 0
    v_add_f32_dpp v246, v246, v246 row_shr:1 row_mask:0xf bank_mask:0xf bound_ctrl:0
    v_mfma_f32_16x16x32_bf16 v[40:43], v[188:191], v[164:167], v[40:43]
    s_nop 0
    v_add_f32_dpp v246, v246, v246 row_shr:2 row_mask:0xf bank_mask:0xf bound_ctrl:0
    s_waitcnt lgkmcnt(0)
    v_mfma_f32_16x16x32_bf16 v[32:35], v[148:151], v[132:135], v[32:35]
    ds_read_b64_tr_b16 v[180:181], v14 offset:49152
    s_cmp_lt_u32 s28, 2
    s_cbranch_scc0 K_nort2
    buffer_store_dwordx4 v[200:203], v2, s[20:23], s47 offen sc1
K_nort2:
    s_nop 0
    v_add_f32_dpp v246, v246, v246 row_shr:4 row_mask:0xf bank_mask:0xf bound_ctrl:0
    v_mfma_f32_16x16x32_bf16 v[48:51], v[148:151], v[136:139], v[48:51]
    ds_read_b64_tr_b16 v[182:183], v14 offset:49664
    s_nop 0
    v_add_f32_dpp v246, v246, v246 row_shr:8 row_mask:0xf bank_mask:0xf bound_ctrl:0
    v_mfma_f32_16x16x32_bf16 v[64:67], v[148:151], v[140:143], v[64:67]
    ds_read_b64_tr_b16 v[184:185], v15 offset:49152
    s_nop 0
    v_add_f32_dpp v246, v246, v246 row_bcast:15 row_mask:0xa bank_mask:0xf
    s_add_u32 m0, s3, 2048
    v_mfma_f32_16x16x32_bf16 v[80:83], v[148:151], v[144:147], v[80:83]
    ds_read_b64_tr_b16 v[186:187], v15 offset:49664
    buffer_load_dwordx4 v22, s[8:11], s33 offen lds
    s_nop 0
    v_add_f32_dpp v246, v246, v246 row_bcast:31 row_mask:0xc bank_mask:0xf
    v_mfma_f32_16x16x32_bf16 v[84:87], v[152:155], v[144:147], v[84:87]
    ds_read_b64_tr_b16 v[188:189], v14 offset:57344
    v_readlane_b32 s60, v246, 63
    v_mfma_f32_16x16x32_bf16 v[68:71], v[152:155], v[140:143], v[68:71]
    ds_read_b64_tr_b16 v[190:191], v14 offset:57856
    buffer_store_dwordx4 v[196:199], v2, s[20:23], s46 offen sc1
    s_nop 0
    v_mul_f32 v248, s60, v255
    v_sub_f32 v236, v236, v248
    v_mfma_f32_16x16x32_bf16 v[52:55], v[152:155], v[136:139], v[52:55]
    ds_read_b64_tr_b16 v[192:193], v15 offset:57344
    buffer_load_dwordx2 v[6:7], v4, s[76:79], 0 offen sc1
    v_sub_f32 v237, v237, v248
    v_sub_f32 v238, v238, v248
    v_mfma_f32_16x16x32_bf16 v[36:39], v[152:155], v[132:135], v[36:39]
    ds_read_b64_tr_b16 v[194:195], v15 offset:57856
    v_sub_f32 v239, v239, v248
    v_sub_f32 v240, v240, v248
    s_add_u32 m0, s3, 3072
    v_mfma_f32_16x16x32_bf16 v[44:47], v[160:163], v[132:135], v[44:47]
    ds_read_b128 v[164:167], v9 offset:49152
    buffer_load_dwordx4 v23, s[8:11], s33 offen lds
    v_sub_f32 v241, v241, v248
    v_sub_f32 v242, v242, v248
    v_mfma_f32_16x16x32_bf16 v[60:63], v[160:163], v[136:139], v[60:63]
    ds_read_b128 v[168:171], v9 offset:51200
    v_sub_f32 v243, v243, v248
    v_sub_f32 v244, v244, v248
    v_mfma_f32_16x16x32_bf16 v[76:79], v[160:163], v[140:143], v[76:79]
    ds_read_b128 v[172:175], v9 offset:53248
    v_sub_f32 v245, v245, v248
    v_mul_f32 v246, v236, v236
    v_mfma_f32_16x16x32_bf16 v[92:95], v[160:163], v[144:147], v[92:95]
    ds_read_b128 v[176:179], v9 offset:55296
    v_mul_f32 v247, v237, v237
    v_fmac_f32 v246, v238, v238
    v_mfma_f32_16x16x32_bf16 v[88:91], v[156:159], v[144:147], v[88:91]
    v_fmac_f32 v247, v239, v239
    v_fmac_f32 v246, v240, v240
    s_add_u32 m0, s37, 0
    v_mfma_f32_16x16x32_bf16 v[72:75], v[156:159], v[140:143], v[72:75]
    buffer_load_dwordx4 v24, s[12:15], s34 offen lds
    v_fmac_f32 v247, v241, v241
    v_fmac_f32 v246, v242, v242
    v_mfma_f32_16x16x32_bf16 v[56:59], v[156:159], v[136:139], v[56:59]
    v_fmac_f32 v247, v243, v243
    v_fmac_f32 v246, v244, v244
    v_mfma_f32_16x16x32_bf16 v[40:43], v[156:159], v[132:135], v[40:43]
    v_fmac_f32 v247, v245, v245
    v_add_f32 v246, v246, v247
    s_cmp_eq_u32 s74, 0
    s_cbranch_scc1 K_ncs1
    v_mfma_f32_16x16x32_bf16 v[212:215], v[228:231], v[148:151], 0
    v_mfma_f32_16x16x32_bf16 v[216:219], v[228:231], v[152:155], 0
    v_mfma_f32_16x16x32_bf16 v[220:223], v[228:231], v[156:159], 0
    v_mfma_f32_16x16x32_bf16 v[224:227], v[228:231], v[160:163], 0
K_ncs1:
    s_waitcnt lgkmcnt(0)
    v_mfma_f32_16x16x32_bf16 v[32:35], v[180:183], v[164:167], v[32:35]
    s_nop 0
    v_add_f32_dpp v246, v246, v246 row_shr:1 row_mask:0xf bank_mask:0xf bound_ctrl:0
    s_add_u32 m0, s37, 8192
    v_mfma_f32_16x16x32_bf16 v[48:51], v[180:183], v[168:171], v[48:51]
    buffer_load_dwordx4 v24, s[16:19], s34 offen lds
    s_nop 0
    v_add_f32_dpp v246, v246, v246 row_shr:2 row_mask:0xf bank_mask:0xf bound_ctrl:0
    v_mfma_f32_16x16x32_bf16 v[64:67], v[180:183], v[172:175], v[64:67]
    s_waitcnt vmcnt(8)
    s_barrier
    ds_read_b64_tr_b16 v[148:149], v16 offset:0
    s_nop 0
    v_add_f32_dpp v246, v246, v246 row_shr:4 row_mask:0xf bank_mask:0xf bound_ctrl:0
    v_mfma_f32_16x16x32_bf16 v[80:83], v[180:183], v[176:179], v[80:83]
    ds_read_b64_tr_b16 v[150:151], v16 offset:512
    s_nop 0
    v_add_f32_dpp v246, v246, v246 row_shr:8 row_mask:0xf bank_mask:0xf bound_ctrl:0
    v_mfma_f32_16x16x32_bf16 v[84:87], v[184:187], v[176:179], v[84:87]
    ds_read_b64_tr_b16 v[152:153], v17 offset:0
    s_nop 0
    v_add_f32_dpp v246, v246, v246 row_bcast:15 row_mask:0xa bank_mask:0xf
    v_mfma_f32_16x16x32_bf16 v[68:71], v[184:187], v[172:175], v[68:71]
    ds_read_b64_tr_b16 v[154:155], v17 offset:512
    s_nop 0
    v_add_f32_dpp v246, v246, v246 row_bcast:31 row_mask:0xc bank_mask:0xf
    v_mfma_f32_16x16x32_bf16 v[52:55], v[184:187], v[168:171], v[52:55]
    ds_read_b64_tr_b16 v[156:157], v16 offset:8192
    v_readlane_b32 s60, v246, 63
    v_mfma_f32_16x16x32_bf16 v[36:39], v[184:187], v[164:167], v[36:39]
    ds_read_b64_tr_b16 v[158:159], v16 offset:8704
    v_mov_b32 v250, 925353388
    v_fma_f32 v250, s60, v255, v250
    v_rsq_f32 v249, v250
    v_mfma_f32_16x16x32_bf16 v[44:47], v[192:195], v[164:167], v[44:47]
    ds_read_b64_tr_b16 v[160:161], v17 offset:8192
    buffer_store_dwordx3 v[248:250], v254, s[20:23], s38 offen sc1
    v_mfma_f32_16x16x32_bf16 v[60:63], v[192:195], v[168:171], v[60:63]
    ds_read_b64_tr_b16 v[162:163], v17 offset:8704
    s_cmp_eq_u32 s49, 0
    s_cselect_b32 s69, 2146435072, s69
    s_mov_b32 s80, 0xffff0000
    s_mov_b32 s81, 0xffff0000
    s_mov_b32 s82, 0
    s_mov_b32 s83, -1
    v_cndmask_b32 v212, v212, v216, s[80:81]
    v_cndmask_b32 v220, v220, v224, s[80:81]
    v_cndmask_b32 v212, v212, v220, s[82:83]
    buffer_store_dword v212, v30, s[20:23], s69 offen sc1
    v_mfma_f32_16x16x32_bf16 v[76:79], v[192:195], v[172:175], v[76:79]
    ds_read_b128 v[132:135], v10 offset:0
    s_lshl_b32 s33, s32, 7
    s_mul_i32 s34, s32, s35
    s_add_u32 s32, s32, 1
    s_cmp_eq_u32 s32, 10
    s_cselect_b32 s32, 0, s32
    s_add_u32 m0, s36, 49152
    v_mfma_f32_16x16x32_bf16 v[92:95], v[192:195], v[176:179], v[92:95]
    ds_read_b128 v[136:139], v10 offset:2048
    buffer_load_dwordx4 v20, s[8:11], s33 offen lds
    v_mfma_f32_16x16x32_bf16 v[88:91], v[188:191], v[176:179], v[88:91]
    ds_read_b128 v[140:143], v10 offset:4096
    v_mfma_f32_16x16x32_bf16 v[72:75], v[188:191], v[172:175], v[72:75]
    ds_read_b128 v[144:147], v10 offset:6144
    s_add_u32 m0, s36, 50176
    v_mfma_f32_16x16x32_bf16 v[56:59], v[188:191], v[168:171], v[56:59]
    buffer_load_dwordx4 v21, s[8:11], s33 offen lds
    v_mfma_f32_16x16x32_bf16 v[40:43], v[188:191], v[164:167], v[40:43]
    s_waitcnt lgkmcnt(0)
    v_mfma_f32_16x16x32_bf16 v[32:35], v[148:151], v[132:135], v[32:35]
    ds_read_b64_tr_b16 v[180:181], v18 offset:0
    v_mfma_f32_16x16x32_bf16 v[48:51], v[148:151], v[136:139], v[48:51]
    ds_read_b64_tr_b16 v[182:183], v18 offset:512
    v_mfma_f32_16x16x32_bf16 v[64:67], v[148:151], v[140:143], v[64:67]
    ds_read_b64_tr_b16 v[184:185], v19 offset:0
    s_add_u32 m0, s3, 51200
    v_mfma_f32_16x16x32_bf16 v[80:83], v[148:151], v[144:147], v[80:83]
    ds_read_b64_tr_b16 v[186:187], v19 offset:512
    buffer_load_dwordx4 v22, s[8:11], s33 offen lds
    v_mfma_f32_16x16x32_bf16 v[84:87], v[152:155], v[144:147], v[84:87]
    ds_read_b64_tr_b16 v[188:189], v18 offset:8192
    v_mfma_f32_16x16x32_bf16 v[68:71], v[152:155], v[140:143], v[68:71]
    ds_read_b64_tr_b16 v[190:191], v18 offset:8704
    v_mfma_f32_16x16x32_bf16 v[52:55], v[152:155], v[136:139], v[52:55]
    ds_read_b64_tr_b16 v[192:193], v19 offset:8192
    v_mfma_f32_16x16x32_bf16 v[36:39], v[152:155], v[132:135], v[36:39]
    ds_read_b64_tr_b16 v[194:195], v19 offset:8704
    s_add_u32 m0, s3, 52224
    v_mfma_f32_16x16x32_bf16 v[44:47], v[160:163], v[132:135], v[44:47]
    ds_read_b128 v[164:167], v11 offset:0
    buffer_load_dwordx4 v23, s[8:11], s33 offen lds
    v_mfma_f32_16x16x32_bf16 v[60:63], v[160:163], v[136:139], v[60:63]
    ds_read_b128 v[168:171], v11 offset:2048
    v_mfma_f32_16x16x32_bf16 v[76:79], v[160:163], v[140:143], v[76:79]
    ds_read_b128 v[172:175], v11 offset:4096
    v_mfma_f32_16x16x32_bf16 v[92:95], v[160:163], v[144:147], v[92:95]
    ds_read_b128 v[176:179], v11 offset:6144
    v_mfma_f32_16x16x32_bf16 v[88:91], v[156:159], v[144:147], v[88:91]
    s_add_u32 m0, s37, 49152
    v_mfma_f32_16x16x32_bf16 v[72:75], v[156:159], v[140:143], v[72:75]
    buffer_load_dwordx4 v24, s[12:15], s34 offen lds
    v_mfma_f32_16x16x32_bf16 v[56:59], v[156:159], v[136:139], v[56:59]
    v_mfma_f32_16x16x32_bf16 v[40:43], v[156:159], v[132:135], v[40:43]
    s_waitcnt lgkmcnt(0)
    v_mfma_f32_16x16x32_bf16 v[32:35], v[180:183], v[164:167], v[32:35]
    s_add_u32 m0, s37, 57344
    v_mfma_f32_16x16x32_bf16 v[48:51], v[180:183], v[168:171], v[48:51]
    buffer_load_dwordx4 v24, s[16:19], s34 offen lds
    v_mfma_f32_16x16x32_bf16 v[64:67], v[180:183], v[172:175], v[64:67]
    s_waitcnt vmcnt(8)
    s_barrier
    ds_read_b64_tr_b16 v[148:149], v12 offset:0
    v_mfma_f32_16x16x32_bf16 v[80:83], v[180:183], v[176:179], v[80:83]
    ds_read_b64_tr_b16 v[150:151], v12 offset:512
    v_mfma_f32_16x16x32_bf16 v[84:87], v[184:187], v[176:179], v[84:87]
    ds_read_b64_tr_b16 v[152:153], v13 offset:0
    v_mfma_f32_16x16x32_bf16 v[68:71], v[184:187], v[172:175], v[68:71]
    ds_read_b64_tr_b16 v[154:155], v13 offset:512
    v_mfma_f32_16x16x32_bf16 v[52:55], v[184:187], v[168:171], v[52:55]
    ds_read_b64_tr_b16 v[156:157], v12 offset:8192
    v_mfma_f32_16x16x32_bf16 v[36:39], v[184:187], v[164:167], v[36:39]
    ds_read_b64_tr_b16 v[158:159], v12 offset:8704
    v_mfma_f32_16x16x32_bf16 v[44:47], v[192:195], v[164:167], v[44:47]
    ds_read_b64_tr_b16 v[160:161], v13 offset:8192
    v_mfma_f32_16x16x32_bf16 v[60:63], v[192:195], v[168:171], v[60:63]
    ds_read_b64_tr_b16 v[162:163], v13 offset:8704
    v_readfirstlane_b32 s72, v6
    v_readfirstlane_b32 s73, v7
    s_nop 0
    s_cmp_eq_u32 s72, 0
    s_cbranch_scc1 K_slow0F
K_back0F:
    v_mfma_f32_16x16x32_bf16 v[76:79], v[192:195], v[172:175], v[76:79]
    ds_read_b128 v[132:135], v8 offset:0
    s_lshl_b32 s33, s32, 7
    s_mul_i32 s34, s32, s35
    s_add_u32 s32, s32, 1
    s_cmp_eq_u32 s32, 10
    s_cselect_b32 s32, 0, s32
    s_add_u32 m0, s36, 98304
    v_mfma_f32_16x16x32_bf16 v[92:95], v[192:195], v[176:179], v[92:95]
    ds_read_b128 v[136:139], v8 offset:2048
    buffer_load_dwordx4 v20, s[8:11], s33 offen lds
    v_mfma_f32_16x16x32_bf16 v[88:91], v[188:191], v[176:179], v[88:91]
    ds_read_b128 v[140:143], v8 offset:4096
    v_mfma_f32_16x16x32_bf16 v[72:75], v[188:191], v[172:175], v[72:75]
    ds_read_b128 v[144:147], v8 offset:6144
    s_add_u32 m0, s36, 99328
    v_mfma_f32_16x16x32_bf16 v[56:59], v[188:191], v[168:171], v[56:59]
    buffer_load_dwordx4 v21, s[8:11], s33 offen lds
    v_mfma_f32_16x16x32_bf16 v[40:43], v[188:191], v[164:167], v[40:43]
    s_waitcnt lgkmcnt(0)
    v_mfma_f32_16x16x32_bf16 v[32:35], v[148:151], v[132:135], v[32:35]
    ds_read_b64_tr_b16 v[180:181], v14 offset:0
    v_mfma_f32_16x16x32_bf16 v[48:51], v[148:151], v[136:139], v[48:51]
    ds_read_b64_tr_b16 v[182:183], v14 offset:512
    v_mfma_f32_16x16x32_bf16 v[64:67], v[148:151], v[140:143], v[64:67]
    ds_read_b64_tr_b16 v[184:185], v15 offset:0
    s_add_u32 m0, s3, 100352
    v_mfma_f32_16x16x32_bf16 v[80:83], v[148:151], v[144:147], v[80:83]
    ds_read_b64_tr_b16 v[186:187], v15 offset:512
    buffer_load_dwordx4 v22, s[8:11], s33 offen lds
    v_mfma_f32_16x16x32_bf16 v[84:87], v[152:155], v[144:147], v[84:87]
    ds_read_b64_tr_b16 v[188:189], v14 offset:8192
    v_mfma_f32_16x16x32_bf16 v[68:71], v[152:155], v[140:143], v[68:71]
    ds_read_b64_tr_b16 v[190:191], v14 offset:8704
    v_mfma_f32_16x16x32_bf16 v[52:55], v[152:155], v[136:139], v[52:55]
    ds_read_b64_tr_b16 v[192:193], v15 offset:8192
    v_mfma_f32_16x16x32_bf16 v[36:39], v[152:155], v[132:135], v[36:39]
    ds_read_b64_tr_b16 v[194:195], v15 offset:8704
    s_add_u32 m0, s3, 101376
    v_mfma_f32_16x16x32_bf16 v[44:47], v[160:163], v[132:135], v[44:47]
    ds_read_b128 v[164:167], v9 offset:0
    buffer_load_dwordx4 v23, s[8:11], s33 offen lds
    v_mfma_f32_16x16x32_bf16 v[60:63], v[160:163], v[136:139], v[60:63]
    ds_read_b128 v[168:171], v9 offset:2048
    v_mfma_f32_16x16x32_bf16 v[76:79], v[160:163], v[140:143], v[76:79]
    ds_read_b128 v[172:175], v9 offset:4096
    v_mfma_f32_16x16x32_bf16 v[92:95], v[160:163], v[144:147], v[92:95]
    ds_read_b128 v[176:179], v9 offset:6144
    v_mfma_f32_16x16x32_bf16 v[88:91], v[156:159], v[144:147], v[88:91]
    s_add_u32 m0, s37, 98304
    v_mfma_f32_16x16x32_bf16 v[72:75], v[156:159], v[140:143], v[72:75]
    buffer_load_dwordx4 v24, s[12:15], s34 offen lds
    v_mfma_f32_16x16x32_bf16 v[56:59], v[156:159], v[136:139], v[56:59]
    v_mfma_f32_16x16x32_bf16 v[40:43], v[156:159], v[132:135], v[40:43]
    s_waitcnt lgkmcnt(0)
    v_mfma_f32_16x16x32_bf16 v[32:35], v[180:183], v[164:167], v[32:35]
    s_add_u32 m0, s37, 106496
    v_mfma_f32_16x16x32_bf16 v[48:51], v[180:183], v[168:171], v[48:51]
    buffer_load_dwordx4 v24, s[16:19], s34 offen lds
    v_mfma_f32_16x16x32_bf16 v[64:67], v[180:183], v[172:175], v[64:67]
    s_waitcnt vmcnt(6)
    s_barrier
    ds_read_b64_tr_b16 v[148:149], v12 offset:49152
    v_mfma_f32_16x16x32_bf16 v[80:83], v[180:183], v[176:179], v[80:83]
    ds_read_b64_tr_b16 v[150:151], v12 offset:49664
    v_mfma_f32_16x16x32_bf16 v[84:87], v[184:187], v[176:179], v[84:87]
    ds_read_b64_tr_b16 v[152:153], v13 offset:49152
    v_mfma_f32_16x16x32_bf16 v[68:71], v[184:187], v[172:175], v[68:71]
    ds_read_b64_tr_b16 v[154:155], v13 offset:49664
    v_mfma_f32_16x16x32_bf16 v[52:55], v[184:187], v[168:171], v[52:55]
    ds_read_b64_tr_b16 v[156:157], v12 offset:57344
    v_mfma_f32_16x16x32_bf16 v[36:39], v[184:187], v[164:167], v[36:39]
    ds_read_b64_tr_b16 v[158:159], v12 offset:57856
    v_mfma_f32_16x16x32_bf16 v[44:47], v[192:195], v[164:167], v[44:47]
    ds_read_b64_tr_b16 v[160:161], v13 offset:57344
    v_mfma_f32_16x16x32_bf16 v[60:63], v[192:195], v[168:171], v[60:63]
    ds_read_b64_tr_b16 v[162:163], v13 offset:57856
    s_cmp_eq_u32 s28, 0
    s_cbranch_scc0 K_nf1F
    buffer_store_dwordx2 v[6:7], v31, s[20:23], s48 offen sc1
K_nf1F:
    v_mfma_f32_16x16x32_bf16 v[76:79], v[192:195], v[172:175], v[76:79]
    ds_read_b128 v[132:135], v8 offset:49152
    s_lshl_b32 s33, s32, 7
    s_mul_i32 s34, s32, s35
    s_add_u32 s32, s32, 1
    s_cmp_eq_u32 s32, 10
    s_cselect_b32 s32, 0, s32
    s_add_u32 m0, s36, 0
    v_mfma_f32_16x16x32_bf16 v[92:95], v[192:195], v[176:179], v[92:95]
    ds_read_b128 v[136:139], v8 offset:51200
    buffer_load_dwordx4 v20, s[8:11], s33 offen lds
    v_mfma_f32_16x16x32_bf16 v[88:91], v[188:191], v[176:179], v[88:91]
    ds_read_b128 v[140:143], v8 offset:53248
    v_mfma_f32_16x16x32_bf16 v[72:75], v[188:191], v[172:175], v[72:75]
    ds_read_b128 v[144:147], v8 offset:55296
    s_add_u32 m0, s36, 1024
    v_mfma_f32_16x16x32_bf16 v[56:59], v[188:191], v[168:171], v[56:59]
    buffer_load_dwordx4 v21, s[8:11], s33 offen lds
    v_mfma_f32_16x16x32_bf16 v[40:43], v[188:191], v[164:167], v[40:43]
    s_waitcnt lgkmcnt(0)
    v_mfma_f32_16x16x32_bf16 v[32:35], v[148:151], v[132:135], v[32:35]
    ds_read_b64_tr_b16 v[180:181], v14 offset:49152
    v_mfma_f32_16x16x32_bf16 v[48:51], v[148:151], v[136:139], v[48:51]
    ds_read_b64_tr_b16 v[182:183], v14 offset:49664
    v_mfma_f32_16x16x32_bf16 v[64:67], v[148:151], v[140:143], v[64:67]
    ds_read_b64_tr_b16 v[184:185], v15 offset:49152
    s_add_u32 m0, s3, 2048
    v_mfma_f32_16x16x32_bf16 v[80:83], v[148:151], v[144:147], v[80:83]
    ds_read_b64_tr_b16 v[186:187], v15 offset:49664
    buffer_load_dwordx4 v22, s[8:11], s33 offen lds
    v_mfma_f32_16x16x32_bf16 v[84:87], v[152:155], v[144:147], v[84:87]
    ds_read_b64_tr_b16 v[188:189], v14 offset:57344
    v_mfma_f32_16x16x32_bf16 v[68:71], v[152:155], v[140:143], v[68:71]
    ds_read_b64_tr_b16 v[190:191], v14 offset:57856
    v_mfma_f32_16x16x32_bf16 v[52:55], v[152:155], v[136:139], v[52:55]
    ds_read_b64_tr_b16 v[192:193], v15 offset:57344
    v_mfma_f32_16x16x32_bf16 v[36:39], v[152:155], v[132:135], v[36:39]
    ds_read_b64_tr_b16 v[194:195], v15 offset:57856
    s_add_u32 m0, s3, 3072
    v_mfma_f32_16x16x32_bf16 v[44:47], v[160:163], v[132:135], v[44:47]
    ds_read_b128 v[164:167], v9 offset:49152
    buffer_load_dwordx4 v23, s[8:11], s33 offen lds
    v_mfma_f32_16x16x32_bf16 v[60:63], v[160:163], v[136:139], v[60:63]
    ds_read_b128 v[168:171], v9 offset:51200
    v_mfma_f32_16x16x32_bf16 v[76:79], v[160:163], v[140:143], v[76:79]
    ds_read_b128 v[172:175], v9 offset:53248
    v_mfma_f32_16x16x32_bf16 v[92:95], v[160:163], v[144:147], v[92:95]
    ds_read_b128 v[176:179], v9 offset:55296
    v_mfma_f32_16x16x32_bf16 v[88:91], v[156:159], v[144:147], v[88:91]
    s_add_u32 m0, s37, 0
    v_mfma_f32_16x16x32_bf16 v[72:75], v[156:159], v[140:143], v[72:75]
    buffer_load_dwordx4 v24, s[12:15], s34 offen lds
    v_mfma_f32_16x16x32_bf16 v[56:59], v[156:159], v[136:139], v[56:59]
    v_mfma_f32_16x16x32_bf16 v[40:43], v[156:159], v[132:135], v[40:43]
    s_waitcnt lgkmcnt(0)
    v_mfma_f32_16x16x32_bf16 v[32:35], v[180:183], v[164:167], v[32:35]
    s_add_u32 m0, s37, 8192
    v_mfma_f32_16x16x32_bf16 v[48:51], v[180:183], v[168:171], v[48:51]
    buffer_load_dwordx4 v24, s[16:19], s34 offen lds
    v_mfma_f32_16x16x32_bf16 v[64:67], v[180:183], v[172:175], v[64:67]
    s_waitcnt vmcnt(6)
    s_barrier
    ds_read_b64_tr_b16 v[148:149], v16 offset:0
    v_mfma_f32_16x16x32_bf16 v[80:83], v[180:183], v[176:179], v[80:83]
    ds_read_b64_tr_b16 v[150:151], v16 offset:512
    v_mfma_f32_16x16x32_bf16 v[84:87], v[184:187], v[176:179], v[84:87]
    ds_read_b64_tr_b16 v[152:153], v17 offset:0
    v_mfma_f32_16x16x32_bf16 v[68:71], v[184:187], v[172:175], v[68:71]
    ds_read_b64_tr_b16 v[154:155], v17 offset:512
    v_mfma_f32_16x16x32_bf16 v[52:55], v[184:187], v[168:171], v[52:55]
    ds_read_b64_tr_b16 v[156:157], v16 offset:8192
    v_mfma_f32_16x16x32_bf16 v[36:39], v[184:187], v[164:167], v[36:39]
    ds_read_b64_tr_b16 v[158:159], v16 offset:8704
    v_mfma_f32_16x16x32_bf16 v[44:47], v[192:195], v[164:167], v[44:47]
    ds_read_b64_tr_b16 v[160:161], v17 offset:8192
    v_mfma_f32_16x16x32_bf16 v[60:63], v[192:195], v[168:171], v[60:63]
    ds_read_b64_tr_b16 v[162:163], v17 offset:8704
    v_mfma_f32_16x16x32_bf16 v[76:79], v[192:195], v[172:175], v[76:79]
    ds_read_b128 v[132:135], v10 offset:0
    s_lshl_b32 s33, s32, 7
    s_mul_i32 s34, s32, s35
    s_add_u32 s32, s32, 1
    s_cmp_eq_u32 s32, 10
    s_cselect_b32 s32, 0, s32
    s_add_u32 m0, s36, 49152
    v_mfma_f32_16x16x32_bf16 v[92:95], v[192:195], v[176:179], v[92:95]
    ds_read_b128 v[136:139], v10 offset:2048
    buffer_load_dwordx4 v20, s[8:11], s33 offen lds
    v_mfma_f32_16x16x32_bf16 v[88:91], v[188:191], v[176:179], v[88:91]
    ds_read_b128 v[140:143], v10 offset:4096
    v_mfma_f32_16x16x32_bf16 v[72:75], v[188:191], v[172:175], v[72:75]
    ds_read_b128 v[144:147], v10 offset:6144
    s_add_u32 m0, s36, 50176
    v_mfma_f32_16x16x32_bf16 v[56:59], v[188:191], v[168:171], v[56:59]
    buffer_load_dwordx4 v21, s[8:11], s33 offen lds
    v_mfma_f32_16x16x32_bf16 v[40:43], v[188:191], v[164:167], v[40:43]
    s_waitcnt lgkmcnt(0)
    v_mfma_f32_16x16x32_bf16 v[32:35], v[148:151], v[132:135], v[32:35]
    ds_read_b64_tr_b16 v[180:181], v18 offset:0
    v_mfma_f32_16x16x32_bf16 v[48:51], v[148:151], v[136:139], v[48:51]
    ds_read_b64_tr_b16 v[182:183], v18 offset:512
    v_mfma_f32_16x16x32_bf16 v[64:67], v[148:151], v[140:143], v[64:67]
    ds_read_b64_tr_b16 v[184:185], v19 offset:0
    s_add_u32 m0, s3, 51200
    v_mfma_f32_16x16x32_bf16 v[80:83], v[148:151], v[144:147], v[80:83]
    ds_read_b64_tr_b16 v[186:187], v19 offset:512
    buffer_load_dwordx4 v22, s[8:11], s33 offen lds
    v_mfma_f32_16x16x32_bf16 v[84:87], v[152:155], v[144:147], v[84:87]
    ds_read_b64_tr_b16 v[188:189], v18 offset:8192
    v_mfma_f32_16x16x32_bf16 v[68:71], v[152:155], v[140:143], v[68:71]
    ds_read_b64_tr_b16 v[190:191], v18 offset:8704
    v_mfma_f32_16x16x32_bf16 v[52:55], v[152:155], v[136:139], v[52:55]
    ds_read_b64_tr_b16 v[192:193], v19 offset:8192
    v_mfma_f32_16x16x32_bf16 v[36:39], v[152:155], v[132:135], v[36:39]
    ds_read_b64_tr_b16 v[194:195], v19 offset:8704
    s_add_u32 m0, s3, 52224
    v_mfma_f32_16x16x32_bf16 v[44:47], v[160:163], v[132:135], v[44:47]
    ds_read_b128 v[164:167], v11 offset:0
    buffer_load_dwordx4 v23, s[8:11], s33 offen lds
    v_mfma_f32_16x16x32_bf16 v[60:63], v[160:163], v[136:139], v[60:63]
    ds_read_b128 v[168:171], v11 offset:2048
    v_mfma_f32_16x16x32_bf16 v[76:79], v[160:163], v[140:143], v[76:79]
    ds_read_b128 v[172:175], v11 offset:4096
    v_mfma_f32_16x16x32_bf16 v[92:95], v[160:163], v[144:147], v[92:95]
    ds_read_b128 v[176:179], v11 offset:6144
    v_mfma_f32_16x16x32_bf16 v[88:91], v[156:159], v[144:147], v[88:91]
    s_add_u32 m0, s37, 49152
    v_mfma_f32_16x16x32_bf16 v[72:75], v[156:159], v[140:143], v[72:75]
    buffer_load_dwordx4 v24, s[12:15], s34 offen lds
    v_mfma_f32_16x16x32_bf16 v[56:59], v[156:159], v[136:139], v[56:59]
    v_mfma_f32_16x16x32_bf16 v[40:43], v[156:159], v[132:135], v[40:43]
    s_waitcnt lgkmcnt(0)
    v_mfma_f32_16x16x32_bf16 v[32:35], v[180:183], v[164:167], v[32:35]
    s_add_u32 m0, s37, 57344
    v_mfma_f32_16x16x32_bf16 v[48:51], v[180:183], v[168:171], v[48:51]
    buffer_load_dwordx4 v24, s[16:19], s34 offen lds
    v_mfma_f32_16x16x32_bf16 v[64:67], v[180:183], v[172:175], v[64:67]
    s_waitcnt vmcnt(6)
    s_barrier
    ds_read_b64_tr_b16 v[148:149], v12 offset:0
    v_mfma_f32_16x16x32_bf16 v[80:83], v[180:183], v[176:179], v[80:83]
    ds_read_b64_tr_b16 v[150:151], v12 offset:512
    v_mfma_f32_16x16x32_bf16 v[84:87], v[184:187], v[176:179], v[84:87]
    ds_read_b64_tr_b16 v[152:153], v13 offset:0
    v_mfma_f32_16x16x32_bf16 v[68:71], v[184:187], v[172:175], v[68:71]
    ds_read_b64_tr_b16 v[154:155], v13 offset:512
    v_mfma_f32_16x16x32_bf16 v[52:55], v[184:187], v[168:171], v[52:55]
    ds_read_b64_tr_b16 v[156:157], v12 offset:8192
    v_mfma_f32_16x16x32_bf16 v[36:39], v[184:187], v[164:167], v[36:39]
    ds_read_b64_tr_b16 v[158:159], v12 offset:8704
    v_mfma_f32_16x16x32_bf16 v[44:47], v[192:195], v[164:167], v[44:47]
    ds_read_b64_tr_b16 v[160:161], v13 offset:8192
    v_mfma_f32_16x16x32_bf16 v[60:63], v[192:195], v[168:171], v[60:63]
    ds_read_b64_tr_b16 v[162:163], v13 offset:8704
    v_mfma_f32_16x16x32_bf16 v[76:79], v[192:195], v[172:175], v[76:79]
    ds_read_b128 v[132:135], v8 offset:0
    s_lshl_b32 s33, s32, 7
    s_mul_i32 s34, s32, s35
    s_add_u32 s32, s32, 1
    s_cmp_eq_u32 s32, 10
    s_cselect_b32 s32, 0, s32
    s_add_u32 m0, s36, 98304
    v_mfma_f32_16x16x32_bf16 v[92:95], v[192:195], v[176:179], v[92:95]
    ds_read_b128 v[136:139], v8 offset:2048
    buffer_load_dwordx4 v20, s[8:11], s33 offen lds
    v_mfma_f32_16x16x32_bf16 v[88:91], v[188:191], v[176:179], v[88:91]
    ds_read_b128 v[140:143], v8 offset:4096
    v_mfma_f32_16x16x32_bf16 v[72:75], v[188:191], v[172:175], v[72:75]
    ds_read_b128 v[144:147], v8 offset:6144
    s_add_u32 m0, s36, 99328
    v_mfma_f32_16x16x32_bf16 v[56:59], v[188:191], v[168:171], v[56:59]
    buffer_load_dwordx4 v21, s[8:11], s33 offen lds
    v_mfma_f32_16x16x32_bf16 v[40:43], v[188:191], v[164:167], v[40:43]
    s_waitcnt lgkmcnt(0)
    v_mfma_f32_16x16x32_bf16 v[32:35], v[148:151], v[132:135], v[32:35]
    ds_read_b64_tr_b16 v[180:181], v14 offset:0
    v_mfma_f32_16x16x32_bf16 v[48:51], v[148:151], v[136:139], v[48:51]
    ds_read_b64_tr_b16 v[182:183], v14 offset:512
    v_mfma_f32_16x16x32_bf16 v[64:67], v[148:151], v[140:143], v[64:67]
    ds_read_b64_tr_b16 v[184:185], v15 offset:0
    s_add_u32 m0, s3, 100352
    v_mfma_f32_16x16x32_bf16 v[80:83], v[148:151], v[144:147], v[80:83]
    ds_read_b64_tr_b16 v[186:187], v15 offset:512
    buffer_load_dwordx4 v22, s[8:11], s33 offen lds
    v_mfma_f32_16x16x32_bf16 v[84:87], v[152:155], v[144:147], v[84:87]
    ds_read_b64_tr_b16 v[188:189], v14 offset:8192
    v_mfma_f32_16x16x32_bf16 v[68:71], v[152:155], v[140:143], v[68:71]
    ds_read_b64_tr_b16 v[190:191], v14 offset:8704
    s_mov_b32 s61, 15794176
    v_lshlrev_b32 v30, 5, v1
    s_cmp_eq_u32 s28, 7
    s_cbranch_scc0 K_np1F
    buffer_load_dwordx4 v[240:243], v30, s[20:23], s61 offen sc1
    buffer_load_dwordx4 v[244:247], v30, s[20:23], s61 offen offset:16 sc1
K_np1F:
    v_mfma_f32_16x16x32_bf16 v[52:55], v[152:155], v[136:139], v[52:55]
    ds_read_b64_tr_b16 v[192:193], v15 offset:8192
    v_mfma_f32_16x16x32_bf16 v[36:39], v[152:155], v[132:135], v[36:39]
    ds_read_b64_tr_b16 v[194:195], v15 offset:8704
    s_add_u32 m0, s3, 101376
    v_mfma_f32_16x16x32_bf16 v[44:47], v[160:163], v[132:135], v[44:47]
    ds_read_b128 v[164:167], v9 offset:0
    buffer_load_dwordx4 v23, s[8:11], s33 offen lds
    v_mfma_f32_16x16x32_bf16 v[60:63], v[160:163], v[136:139], v[60:63]
    ds_read_b128 v[168:171], v9 offset:2048
    v_mfma_f32_16x16x32_bf16 v[76:79], v[160:163], v[140:143], v[76:79]
    ds_read_b128 v[172:175], v9 offset:4096
    v_mfma_f32_16x16x32_bf16 v[92:95], v[160:163], v[144:147], v[92:95]
    ds_read_b128 v[176:179], v9 offset:6144
    v_mfma_f32_16x16x32_bf16 v[88:91], v[156:159], v[144:147], v[88:91]
    s_add_u32 m0, s37, 98304
    v_mfma_f32_16x16x32_bf16 v[72:75], v[156:159], v[140:143], v[72:75]
    buffer_load_dwordx4 v24, s[12:15], s34 offen lds
    v_mfma_f32_16x16x32_bf16 v[56:59], v[156:159], v[136:139], v[56:59]
    v_mfma_f32_16x16x32_bf16 v[40:43], v[156:159], v[132:135], v[40:43]
    s_waitcnt lgkmcnt(0)
    v_mfma_f32_16x16x32_bf16 v[32:35], v[180:183], v[164:167], v[32:35]
    s_add_u32 m0, s37, 106496
    v_mfma_f32_16x16x32_bf16 v[48:51], v[180:183], v[168:171], v[48:51]
    buffer_load_dwordx4 v24, s[16:19], s34 offen lds
    v_mfma_f32_16x16x32_bf16 v[64:67], v[180:183], v[172:175], v[64:67]
    s_waitcnt vmcnt(6)
    s_barrier
    ds_read_b64_tr_b16 v[148:149], v12 offset:49152
    v_mfma_f32_16x16x32_bf16 v[80:83], v[180:183], v[176:179], v[80:83]
    ds_read_b64_tr_b16 v[150:151], v12 offset:49664
    v_mfma_f32_16x16x32_bf16 v[84:87], v[184:187], v[176:179], v[84:87]
    ds_read_b64_tr_b16 v[152:153], v13 offset:49152
    v_mfma_f32_16x16x32_bf16 v[68:71], v[184:187], v[172:175], v[68:71]
    ds_read_b64_tr_b16 v[154:155], v13 offset:49664
    v_mfma_f32_16x16x32_bf16 v[52:55], v[184:187], v[168:171], v[52:55]
    ds_read_b64_tr_b16 v[156:157], v12 offset:57344
    v_mfma_f32_16x16x32_bf16 v[36:39], v[184:187], v[164:167], v[36:39]
    ds_read_b64_tr_b16 v[158:159], v12 offset:57856
    v_mfma_f32_16x16x32_bf16 v[44:47], v[192:195], v[164:167], v[44:47]
    ds_read_b64_tr_b16 v[160:161], v13 offset:57344
    v_mfma_f32_16x16x32_bf16 v[60:63], v[192:195], v[168:171], v[60:63]
    ds_read_b64_tr_b16 v[162:163], v13 offset:57856
    v_mfma_f32_16x16x32_bf16 v[76:79], v[192:195], v[172:175], v[76:79]
    ds_read_b128 v[132:135], v8 offset:49152
    s_lshl_b32 s33, s32, 7
    s_mul_i32 s34, s32, s35
    s_add_u32 s32, s32, 1
    s_cmp_eq_u32 s32, 10
    s_cselect_b32 s32, 0, s32
    s_add_u32 m0, s36, 0
    v_mfma_f32_16x16x32_bf16 v[92:95], v[192:195], v[176:179], v[92:95]
    ds_read_b128 v[136:139], v8 offset:51200
    buffer_load_dwordx4 v20, s[8:11], s33 offen lds
    v_mfma_f32_16x16x32_bf16 v[88:91], v[188:191], v[176:179], v[88:91]
    ds_read_b128 v[140:143], v8 offset:53248
    v_mfma_f32_16x16x32_bf16 v[72:75], v[188:191], v[172:175], v[72:75]
    ds_read_b128 v[144:147], v8 offset:55296
    s_add_u32 m0, s36, 1024
    v_mfma_f32_16x16x32_bf16 v[56:59], v[188:191], v[168:171], v[56:59]
    buffer_load_dwordx4 v21, s[8:11], s33 offen lds
    v_mfma_f32_16x16x32_bf16 v[40:43], v[188:191], v[164:167], v[40:43]
    s_waitcnt lgkmcnt(0)
    v_mfma_f32_16x16x32_bf16 v[32:35], v[148:151], v[132:135], v[32:35]
    ds_read_b64_tr_b16 v[180:181], v14 offset:49152
    v_mfma_f32_16x16x32_bf16 v[48:51], v[148:151], v[136:139], v[48:51]
    ds_read_b64_tr_b16 v[182:183], v14 offset:49664
    v_mfma_f32_16x16x32_bf16 v[64:67], v[148:151], v[140:143], v[64:67]
    ds_read_b64_tr_b16 v[184:185], v15 offset:49152
    s_add_u32 m0, s3, 2048
    v_mfma_f32_16x16x32_bf16 v[80:83], v[148:151], v[144:147], v[80:83]
    ds_read_b64_tr_b16 v[186:187], v15 offset:49664
    buffer_load_dwordx4 v22, s[8:11], s33 offen lds
    v_mfma_f32_16x16x32_bf16 v[84:87], v[152:155], v[144:147], v[84:87]
    ds_read_b64_tr_b16 v[188:189], v14 offset:57344
    v_mfma_f32_16x16x32_bf16 v[68:71], v[152:155], v[140:143], v[68:71]
    ds_read_b64_tr_b16 v[190:191], v14 offset:57856
    v_mfma_f32_16x16x32_bf16 v[52:55], v[152:155], v[136:139], v[52:55]
    ds_read_b64_tr_b16 v[192:193], v15 offset:57344
    v_mfma_f32_16x16x32_bf16 v[36:39], v[152:155], v[132:135], v[36:39]
    ds_read_b64_tr_b16 v[194:195], v15 offset:57856
    s_add_u32 m0, s3, 3072
    v_mfma_f32_16x16x32_bf16 v[44:47], v[160:163], v[132:135], v[44:47]
    ds_read_b128 v[164:167], v9 offset:49152
    buffer_load_dwordx4 v23, s[8:11], s33 offen lds
    v_mfma_f32_16x16x32_bf16 v[60:63], v[160:163], v[136:139], v[60:63]
    ds_read_b128 v[168:171], v9 offset:51200
    v_mfma_f32_16x16x32_bf16 v[76:79], v[160:163], v[140:143], v[76:79]
    ds_read_b128 v[172:175], v9 offset:53248
    v_mfma_f32_16x16x32_bf16 v[92:95], v[160:163], v[144:147], v[92:95]
    ds_read_b128 v[176:179], v9 offset:55296
    v_mfma_f32_16x16x32_bf16 v[88:91], v[156:159], v[144:147], v[88:91]
    s_add_u32 m0, s37, 0
    v_mfma_f32_16x16x32_bf16 v[72:75], v[156:159], v[140:143], v[72:75]
    buffer_load_dwordx4 v24, s[12:15], s34 offen lds
    v_mfma_f32_16x16x32_bf16 v[56:59], v[156:159], v[136:139], v[56:59]
    v_mfma_f32_16x16x32_bf16 v[40:43], v[156:159], v[132:135], v[40:43]
    s_waitcnt lgkmcnt(0)
    v_mfma_f32_16x16x32_bf16 v[32:35], v[180:183], v[164:167], v[32:35]
    s_add_u32 m0, s37, 8192
    v_mfma_f32_16x16x32_bf16 v[48:51], v[180:183], v[168:171], v[48:51]
    buffer_load_dwordx4 v24, s[16:19], s34 offen lds
    v_mfma_f32_16x16x32_bf16 v[64:67], v[180:183], v[172:175], v[64:67]
    s_waitcnt vmcnt(6)
    s_cmp_eq_u32 s28, 7
    s_cbranch_scc0 K_back1F
    v_cmp_ne_u64 vcc, s[72:73], v[240:241]
    v_cmp_ne_u64 s[80:81], s[72:73], v[242:243]
    v_cmp_ne_u64 s[82:83], s[72:73], v[244:245]
    v_cmp_ne_u64 s[44:45], s[72:73], v[246:247]
    s_nop 0
    s_or_b64 s[80:81], s[80:81], s[82:83]
    s_or_b64 vcc, vcc, s[44:45]
    s_or_b64 vcc, vcc, s[80:81]
    s_cbranch_vccnz K_slow1F
K_back1F:
    s_barrier
    ds_read_b64_tr_b16 v[148:149], v16 offset:0
    v_mfma_f32_16x16x32_bf16 v[80:83], v[180:183], v[176:179], v[80:83]
    ds_read_b64_tr_b16 v[150:151], v16 offset:512
    v_mfma_f32_16x16x32_bf16 v[84:87], v[184:187], v[176:179], v[84:87]
    ds_read_b64_tr_b16 v[152:153], v17 offset:0
    v_mfma_f32_16x16x32_bf16 v[68:71], v[184:187], v[172:175], v[68:71]
    ds_read_b64_tr_b16 v[154:155], v17 offset:512
    v_mfma_f32_16x16x32_bf16 v[52:55], v[184:187], v[168:171], v[52:55]
    ds_read_b64_tr_b16 v[156:157], v16 offset:8192
    v_mfma_f32_16x16x32_bf16 v[36:39], v[184:187], v[164:167], v[36:39]
    ds_read_b64_tr_b16 v[158:159], v16 offset:8704
    v_mfma_f32_16x16x32_bf16 v[44:47], v[192:195], v[164:167], v[44:47]
    ds_read_b64_tr_b16 v[160:161], v17 offset:8192
    v_mfma_f32_16x16x32_bf16 v[60:63], v[192:195], v[168:171], v[60:63]
    ds_read_b64_tr_b16 v[162:163], v17 offset:8704
    s_lshl_b32 s61, s29, 12
    s_add_u32 s61, s61, 15761408
    s_lshl_b32 s54, s55, 10
    v_and_b32 v27, 15, v1
    v_lshl_add_u32 v27, v27, 4, s54
    s_lshl_b32 s54, s56, 8
    s_add_u32 s54, s54, 147456
    v_lshl_add_u32 v26, v1, 2, s54
    s_mul_i32 s46, s30, 10240
    s_lshl_b32 s47, s28, 10
    s_add_u32 s46, s46, s47
    s_add_u32 s46, s46, 15990784
    s_cmp_lt_u32 s28, 2
    s_cbranch_scc0 K_ncsg2
    s_add_u32 m0, s47, 155648
    s_add_u32 s54, s46, 8192
    buffer_load_dwordx4 v2, s[20:23], s54 offen sc1 lds
K_ncsg2:
    s_add_u32 m0, s47, 147456
    s_nop 0
    buffer_load_dwordx4 v2, s[20:23], s46 offen sc1 lds
    v_mfma_f32_16x16x32_bf16 v[76:79], v[192:195], v[172:175], v[76:79]
    ds_read_b128 v[132:135], v10 offset:0
    v_mfma_f32_16x16x32_bf16 v[92:95], v[192:195], v[176:179], v[92:95]
    ds_read_b128 v[136:139], v10 offset:2048
    v_mfma_f32_16x16x32_bf16 v[88:91], v[188:191], v[176:179], v[88:91]
    ds_read_b128 v[140:143], v10 offset:4096
    s_add_u32 s39, s43, 0
    buffer_load_dwordx4 v[196:199], v2, s[20:23], s39 offen offset:0 sc1
    v_mfma_f32_16x16x32_bf16 v[72:75], v[188:191], v[172:175], v[72:75]
    ds_read_b128 v[144:147], v10 offset:6144
    v_mfma_f32_16x16x32_bf16 v[56:59], v[188:191], v[168:171], v[56:59]
    v_mfma_f32_16x16x32_bf16 v[40:43], v[188:191], v[164:167], v[40:43]
    s_waitcnt lgkmcnt(0)
    v_mfma_f32_16x16x32_bf16 v[32:35], v[148:151], v[132:135], v[32:35]
    ds_read_b64_tr_b16 v[180:181], v18 offset:0
    buffer_load_dwordx4 v[200:203], v2, s[20:23], s39 offen offset:1024 sc1
    v_mfma_f32_16x16x32_bf16 v[48:51], v[148:151], v[136:139], v[48:51]
    ds_read_b64_tr_b16 v[182:183], v18 offset:512
    v_mfma_f32_16x16x32_bf16 v[64:67], v[148:151], v[140:143], v[64:67]
    ds_read_b64_tr_b16 v[184:185], v19 offset:0
    v_mfma_f32_16x16x32_bf16 v[80:83], v[148:151], v[144:147], v[80:83]
    ds_read_b64_tr_b16 v[186:187], v19 offset:512
    buffer_load_dwordx4 v[204:207], v2, s[20:23], s39 offen offset:2048 sc1
    v_mfma_f32_16x16x32_bf16 v[84:87], v[152:155], v[144:147], v[84:87]
    ds_read_b64_tr_b16 v[188:189], v18 offset:8192
    v_mfma_f32_16x16x32_bf16 v[68:71], v[152:155], v[140:143], v[68:71]
    ds_read_b64_tr_b16 v[190:191], v18 offset:8704
    v_mfma_f32_16x16x32_bf16 v[52:55], v[152:155], v[136:139], v[52:55]
    ds_read_b64_tr_b16 v[192:193], v19 offset:8192
    v_mfma_f32_16x16x32_bf16 v[36:39], v[152:155], v[132:135], v[36:39]
    ds_read_b64_tr_b16 v[194:195], v19 offset:8704
    buffer_load_dwordx4 v[208:211], v2, s[20:23], s39 offen offset:3072 sc1
    v_mfma_f32_16x16x32_bf16 v[44:47], v[160:163], v[132:135], v[44:47]
    ds_read_b128 v[164:167], v11 offset:0
    v_mfma_f32_16x16x32_bf16 v[60:63], v[160:163], v[136:139], v[60:63]
    ds_read_b128 v[168:171], v11 offset:2048
    v_mfma_f32_16x16x32_bf16 v[76:79], v[160:163], v[140:143], v[76:79]
    ds_read_b128 v[172:175], v11 offset:4096
    buffer_load_dwordx4 v[212:215], v3, s[20:23], s39 offen sc1
    v_mfma_f32_16x16x32_bf16 v[92:95], v[160:163], v[144:147], v[92:95]
    ds_read_b128 v[176:179], v11 offset:6144
    v_mfma_f32_16x16x32_bf16 v[88:91], v[156:159], v[144:147], v[88:91]
    v_mfma_f32_16x16x32_bf16 v[72:75], v[156:159], v[140:143], v[72:75]
    v_mfma_f32_16x16x32_bf16 v[56:59], v[156:159], v[136:139], v[56:59]
    buffer_load_dwordx4 v[116:119], v27, s[20:23], s61 offen offset:0 sc1
    v_mfma_f32_16x16x32_bf16 v[40:43], v[156:159], v[132:135], v[40:43]
    s_waitcnt lgkmcnt(0)
    v_mfma_f32_16x16x32_bf16 v[32:35], v[180:183], v[164:167], v[32:35]
    v_mfma_f32_16x16x32_bf16 v[48:51], v[180:183], v[168:171], v[48:51]
    buffer_load_dwordx4 v[120:123], v27, s[20:23], s61 offen offset:256 sc1
    v_mfma_f32_16x16x32_bf16 v[64:67], v[180:183], v[172:175], v[64:67]
    s_waitcnt vmcnt(7)
    s_barrier
    s_cmp_ge_u32 s28, 4
    s_cbranch_scc0 K_tpF
    s_setprio 1
K_tpF:
    ds_read_b64_tr_b16 v[148:149], v12 offset:0
    v_mfma_f32_16x16x32_bf16 v[80:83], v[180:183], v[176:179], v[80:83]
    ds_read_b64_tr_b16 v[150:151], v12 offset:512
    v_mfma_f32_16x16x32_bf16 v[84:87], v[184:187], v[176:179], v[84:87]
    ds_read_b64_tr_b16 v[152:153], v13 offset:0
    v_mfma_f32_16x16x32_bf16 v[68:71], v[184:187], v[172:175], v[68:71]
    ds_read_b64_tr_b16 v[154:155], v13 offset:512
    buffer_load_dwordx4 v[124:127], v27, s[20:23], s61 offen offset:512 sc1
    v_mfma_f32_16x16x32_bf16 v[52:55], v[184:187], v[168:171], v[52:55]
    ds_read_b64_tr_b16 v[156:157], v12 offset:8192
    v_mfma_f32_16x16x32_bf16 v[36:39], v[184:187], v[164:167], v[36:39]
    ds_read_b64_tr_b16 v[158:159], v12 offset:8704
    v_mfma_f32_16x16x32_bf16 v[44:47], v[192:195], v[164:167], v[44:47]
    ds_read_b64_tr_b16 v[160:161], v13 offset:8192
    buffer_load_dwordx4 v[128:131], v27, s[20:23], s61 offen offset:768 sc1
    v_mfma_f32_16x16x32_bf16 v[60:63], v[192:195], v[168:171], v[60:63]
    ds_read_b64_tr_b16 v[162:163], v13 offset:8704
    s_lshl_b32 s54, s28, 11
    s_add_u32 s54, s54, 86016
    v_add_u32 v30, s54, v2
    ds_write_b128 v30, v[104:107]
    ds_write_b128 v30, v[108:111] offset:1024
    v_lshlrev_b32 v30, 2, v1
    v_add_u32 v30, 143360, v30
    ds_write_b32 v30, v4
    v_mfma_f32_16x16x32_bf16 v[76:79], v[192:195], v[172:175], v[76:79]
    ds_read_b128 v[132:135], v8 offset:0
    ds_read_b32 v96, v26 offset:0
    ds_read_b32 v97, v26 offset:512
    ds_read_b32 v98, v26 offset:1024
    ds_read_b32 v99, v26 offset:1536
    v_mfma_f32_16x16x32_bf16 v[92:95], v[192:195], v[176:179], v[92:95]
    ds_read_b128 v[136:139], v8 offset:2048
    ds_read_b32 v100, v26 offset:2048
    ds_read_b32 v101, v26 offset:2560
    ds_read_b32 v102, v26 offset:3072
    ds_read_b32 v103, v26 offset:3584
    v_mfma_f32_16x16x32_bf16 v[88:91], v[188:191], v[176:179], v[88:91]
    ds_read_b128 v[140:143], v8 offset:4096
    ds_read_b32 v104, v26 offset:4096
    ds_read_b32 v105, v26 offset:4608
    ds_read_b32 v106, v26 offset:5120
    ds_read_b32 v107, v26 offset:5632
    s_add_u32 s39, s43, 5120
    buffer_load_dwordx4 v[216:219], v2, s[20:23], s39 offen offset:0 sc1
    v_mfma_f32_16x16x32_bf16 v[72:75], v[188:191], v[172:175], v[72:75]
    ds_read_b128 v[144:147], v8 offset:6144
    ds_read_b32 v108, v26 offset:6144
    ds_read_b32 v109, v26 offset:6656
    ds_read_b32 v110, v26 offset:7168
    ds_read_b32 v111, v26 offset:7680
    v_mfma_f32_16x16x32_bf16 v[56:59], v[188:191], v[168:171], v[56:59]
    ds_read_b32 v112, v26 offset:8192
    ds_read_b32 v113, v26 offset:8704
    ds_read_b32 v114, v26 offset:9216
    ds_read_b32 v115, v26 offset:9728
    v_mfma_f32_16x16x32_bf16 v[40:43], v[188:191], v[164:167], v[40:43]
    buffer_load_dwordx4 v[220:223], v2, s[20:23], s39 offen offset:1024 sc1
    s_waitcnt lgkmcnt(0)
    v_mfma_f32_16x16x32_bf16 v[32:35], v[148:151], v[132:135], v[32:35]
    ds_read_b64_tr_b16 v[180:181], v14 offset:0
    v_add_f32 v96, v96, v97
    v_add_f32 v98, v98, v99
    v_mfma_f32_16x16x32_bf16 v[48:51], v[148:151], v[136:139], v[48:51]
    ds_read_b64_tr_b16 v[182:183], v14 offset:512
    v_add_f32 v100, v100, v101
    v_add_f32 v102, v102, v103
    v_mfma_f32_16x16x32_bf16 v[64:67], v[148:151], v[140:143], v[64:67]
    ds_read_b64_tr_b16 v[184:185], v15 offset:0
    v_add_f32 v104, v104, v105
    v_add_f32 v106, v106, v107
    v_mfma_f32_16x16x32_bf16 v[80:83], v[148:151], v[144:147], v[80:83]
    ds_read_b64_tr_b16 v[186:187], v15 offset:512
    v_add_f32 v108, v108, v109
    v_add_f32 v110, v110, v111
    buffer_load_dwordx4 v[224:227], v2, s[20:23], s39 offen offset:2048 sc1
    v_mfma_f32_16x16x32_bf16 v[84:87], v[152:155], v[144:147], v[84:87]
    ds_read_b64_tr_b16 v[188:189], v14 offset:8192
    v_add_f32 v112, v112, v113
    v_add_f32 v114, v114, v115
    v_mfma_f32_16x16x32_bf16 v[68:71], v[152:155], v[140:143], v[68:71]
    ds_read_b64_tr_b16 v[190:191], v14 offset:8704
    v_add_f32 v96, v96, v98
    v_add_f32 v100, v100, v102
    v_mfma_f32_16x16x32_bf16 v[52:55], v[152:155], v[136:139], v[52:55]
    ds_read_b64_tr_b16 v[192:193], v15 offset:8192
    v_add_f32 v104, v104, v106
    v_add_f32 v108, v108, v110
    buffer_load_dwordx4 v[228:231], v2, s[20:23], s39 offen offset:3072 sc1
    v_mfma_f32_16x16x32_bf16 v[36:39], v[152:155], v[132:135], v[36:39]
    ds_read_b64_tr_b16 v[194:195], v15 offset:8704
    v_add_f32 v112, v112, v114
    v_add_f32 v96, v96, v100
    v_mfma_f32_16x16x32_bf16 v[44:47], v[160:163], v[132:135], v[44:47]
    ds_read_b128 v[164:167], v9 offset:0
    v_add_f32 v104, v104, v108
    v_add_f32 v96, v96, v112
    v_mfma_f32_16x16x32_bf16 v[60:63], v[160:163], v[136:139], v[60:63]
    ds_read_b128 v[168:171], v9 offset:2048
    s_lshl_b32 s54, s28, 8
    s_add_u32 s54, s54, 157696
    v_lshl_add_u32 v28, v1, 2, s54
    v_add_f32 v96, v96, v104
    v_mfma_f32_16x16x32_bf16 v[76:79], v[160:163], v[140:143], v[76:79]
    ds_read_b128 v[172:175], v9 offset:4096
    v_lshrrev_b32 v26, 4, v1
    v_lshl_add_u32 v26, v26, 4, s54
    ds_write_b32 v28, v96
    buffer_load_dwordx4 v[232:235], v3, s[20:23], s39 offen sc1
    v_mfma_f32_16x16x32_bf16 v[92:95], v[160:163], v[144:147], v[92:95]
    ds_read_b128 v[176:179], v9 offset:6144
    ds_read_b128 v[96:99], v26 offset:0
    v_mfma_f32_16x16x32_bf16 v[88:91], v[156:159], v[144:147], v[88:91]
    ds_read_b128 v[100:103], v26 offset:64
    v_mfma_f32_16x16x32_bf16 v[72:75], v[156:159], v[140:143], v[72:75]
    ds_read_b128 v[104:107], v26 offset:128
    s_add_u32 s39, s43, 10240
    buffer_load_dwordx4 v[236:239], v2, s[20:23], s39 offen offset:0 sc1
    v_mfma_f32_16x16x32_bf16 v[56:59], v[156:159], v[136:139], v[56:59]
    ds_read_b128 v[108:111], v26 offset:192
    v_mfma_f32_16x16x32_bf16 v[40:43], v[156:159], v[132:135], v[40:43]
    s_waitcnt lgkmcnt(0)
    v_mfma_f32_16x16x32_bf16 v[32:35], v[180:183], v[164:167], v[32:35]
    v_mfma_f32_16x16x32_bf16 v[48:51], v[180:183], v[168:171], v[48:51]
    buffer_load_dwordx4 v[240:243], v2, s[20:23], s39 offen offset:1024 sc1
    v_mfma_f32_16x16x32_bf16 v[64:67], v[180:183], v[172:175], v[64:67]
    v_mfma_f32_16x16x32_bf16 v[80:83], v[180:183], v[176:179], v[80:83]
    v_mfma_f32_16x16x32_bf16 v[84:87], v[184:187], v[176:179], v[84:87]
    buffer_load_dwordx4 v[244:247], v2, s[20:23], s39 offen offset:2048 sc1
    v_mfma_f32_16x16x32_bf16 v[68:71], v[184:187], v[172:175], v[68:71]
    v_mfma_f32_16x16x32_bf16 v[52:55], v[184:187], v[168:171], v[52:55]
    v_mfma_f32_16x16x32_bf16 v[36:39], v[184:187], v[164:167], v[36:39]
    v_mfma_f32_16x16x32_bf16 v[44:47], v[192:195], v[164:167], v[44:47]
    buffer_load_dwordx4 v[248:251], v2, s[20:23], s39 offen offset:3072 sc1
    v_mfma_f32_16x16x32_bf16 v[60:63], v[192:195], v[168:171], v[60:63]
    v_mfma_f32_16x16x32_bf16 v[76:79], v[192:195], v[172:175], v[76:79]
    v_mfma_f32_16x16x32_bf16 v[92:95], v[192:195], v[176:179], v[92:95]
    buffer_load_dwordx4 v[252:255], v3, s[20:23], s39 offen sc1
    v_mfma_f32_16x16x32_bf16 v[88:91], v[188:191], v[176:179], v[88:91]
    v_mfma_f32_16x16x32_bf16 v[72:75], v[188:191], v[172:175], v[72:75]
    v_mfma_f32_16x16x32_bf16 v[56:59], v[188:191], v[168:171], v[56:59]
    v_mfma_f32_16x16x32_bf16 v[40:43], v[188:191], v[164:167], v[40:43]
    s_lshl_b32 s61, s30, 1
    s_add_u32 s61, s61, s56
    s_mul_i32 s62, s57, 54
    s_add_u32 s62, s62, s61
    s_lshl_b32 s62, s62, 12
    s_sub_u32 s63, 32, s57
    s_cmp_eq_u32 s57, 0
    s_cselect_b32 s63, 0, s63
    s_mul_i32 s63, s63, 54
    s_add_u32 s63, s63, s61
    s_lshl_b32 s63, s63, 12
    s_add_u32 s63, s63, 2048
    s_waitcnt vmcnt(10) lgkmcnt(0)
    v_mul_f32 v178, v117, v117
    v_mul_f32 v182, v121, v121
    v_mul_f32 v186, v125, v125
    v_mul_f32 v190, v129, v129
    v_mul_f32 v176, 3222493025, v117
    v_mul_f32 v180, 3222493025, v121
    v_mul_f32 v184, 3222493025, v125
    v_mul_f32 v188, 3222493025, v129
    v_mul_f32 v178, v178, v176
    v_mul_f32 v182, v182, v180
    v_mul_f32 v186, v186, v184
    v_mul_f32 v190, v190, v188
    v_mul_f32 v178, 1027024659, v178
    v_mul_f32 v182, 1027024659, v182
    v_mul_f32 v186, 1027024659, v186
    v_mul_f32 v190, 1027024659, v190
    v_pk_fma_f32 v[32:33], v[116:117], v[96:97], v[32:33] op_sel_hi:[0,1,1] neg_lo:[1,0,0] neg_hi:[1,0,0]
    v_pk_fma_f32 v[34:35], v[116:117], v[98:99], v[34:35] op_sel_hi:[0,1,1] neg_lo:[1,0,0] neg_hi:[1,0,0]
    v_pk_fma_f32 v[36:37], v[116:117], v[100:101], v[36:37] op_sel_hi:[0,1,1] neg_lo:[1,0,0] neg_hi:[1,0,0]
    v_pk_fma_f32 v[38:39], v[116:117], v[102:103], v[38:39] op_sel_hi:[0,1,1] neg_lo:[1,0,0] neg_hi:[1,0,0]
    v_pk_mul_f32 v[8:9], v[32:33], v[32:33]
    v_pk_mul_f32 v[10:11], v[34:35], v[34:35]
    v_pk_mul_f32 v[12:13], v[36:37], v[36:37]
    v_pk_mul_f32 v[14:15], v[38:39], v[38:39]
    s_add_u32 s39, s43, 15360
    buffer_load_dwordx4 v[136:139], v2, s[20:23], s39 offen offset:0 sc1
    v_pk_fma_f32 v[8:9], v[8:9], v[178:179], v[176:177] op_sel_hi:[1,0,0]
    v_pk_fma_f32 v[10:11], v[10:11], v[178:179], v[176:177] op_sel_hi:[1,0,0]
    v_pk_fma_f32 v[12:13], v[12:13], v[178:179], v[176:177] op_sel_hi:[1,0,0]
    v_pk_fma_f32 v[14:15], v[14:15], v[178:179], v[176:177] op_sel_hi:[1,0,0]
    v_pk_mul_f32 v[8:9], v[8:9], v[32:33]
    v_pk_mul_f32 v[10:11], v[10:11], v[34:35]
    v_pk_mul_f32 v[12:13], v[12:13], v[36:37]
    v_pk_mul_f32 v[14:15], v[14:15], v[38:39]
    buffer_load_dwordx4 v[140:143], v2, s[20:23], s39 offen offset:1024 sc1
    v_exp_f32 v8, v8
    v_exp_f32 v9, v9
    v_exp_f32 v10, v10
    v_exp_f32 v11, v11
    v_exp_f32 v12, v12
    v_exp_f32 v13, v13
    v_exp_f32 v14, v14
    v_exp_f32 v15, v15
    v_pk_fma_f32 v[40:41], v[116:117], v[104:105], v[40:41] op_sel_hi:[0,1,1] neg_lo:[1,0,0] neg_hi:[1,0,0]
    v_pk_fma_f32 v[42:43], v[116:117], v[106:107], v[42:43] op_sel_hi:[0,1,1] neg_lo:[1,0,0] neg_hi:[1,0,0]
    v_pk_fma_f32 v[44:45], v[116:117], v[108:109], v[44:45] op_sel_hi:[0,1,1] neg_lo:[1,0,0] neg_hi:[1,0,0]
    v_pk_fma_f32 v[46:47], v[116:117], v[110:111], v[46:47] op_sel_hi:[0,1,1] neg_lo:[1,0,0] neg_hi:[1,0,0]
    v_pk_fma_f32 v[8:9], v[8:9], v[118:119], v[118:119] op_sel_hi:[1,0,0]
    v_pk_fma_f32 v[10:11], v[10:11], v[118:119], v[118:119] op_sel_hi:[1,0,0]
    v_pk_fma_f32 v[12:13], v[12:13], v[118:119], v[118:119] op_sel_hi:[1,0,0]
    v_pk_fma_f32 v[14:15], v[14:15], v[118:119], v[118:119] op_sel_hi:[1,0,0]
    v_rcp_f32 v8, v8
    v_rcp_f32 v9, v9
    v_rcp_f32 v10, v10
    v_rcp_f32 v11, v11
    v_rcp_f32 v12, v12
    v_rcp_f32 v13, v13
    v_rcp_f32 v14, v14
    v_rcp_f32 v15, v15
    v_pk_mul_f32 v[32:33], v[32:33], v[40:41]
    v_pk_mul_f32 v[34:35], v[34:35], v[42:43]
    v_pk_mul_f32 v[36:37], v[36:37], v[44:45]
    v_pk_mul_f32 v[38:39], v[38:39], v[46:47]
    v_pk_mul_f32 v[32:33], v[32:33], v[8:9]
    v_pk_mul_f32 v[34:35], v[34:35], v[10:11]
    v_pk_mul_f32 v[36:37], v[36:37], v[12:13]
    v_pk_mul_f32 v[38:39], v[38:39], v[14:15]
    v_cvt_pk_bf16_f32 v40, v32, v33
    v_cvt_pk_bf16_f32 v41, v34, v35
    v_cvt_pk_bf16_f32 v42, v36, v37
    v_cvt_pk_bf16_f32 v43, v38, v39
    buffer_store_dwordx4 v[40:43], v2, s[20:23], s62 offen offset:0 sc1
    v_pk_fma_f32 v[48:49], v[120:121], v[96:97], v[48:49] op_sel_hi:[0,1,1] neg_lo:[1,0,0] neg_hi:[1,0,0]
    v_pk_fma_f32 v[50:51], v[120:121], v[98:99], v[50:51] op_sel_hi:[0,1,1] neg_lo:[1,0,0] neg_hi:[1,0,0]
    v_pk_fma_f32 v[52:53], v[120:121], v[100:101], v[52:53] op_sel_hi:[0,1,1] neg_lo:[1,0,0] neg_hi:[1,0,0]
    v_pk_fma_f32 v[54:55], v[120:121], v[102:103], v[54:55] op_sel_hi:[0,1,1] neg_lo:[1,0,0] neg_hi:[1,0,0]
    v_pk_mul_f32 v[16:17], v[48:49], v[48:49]
    v_pk_mul_f32 v[18:19], v[50:51], v[50:51]
    v_pk_mul_f32 v[20:21], v[52:53], v[52:53]
    v_pk_mul_f32 v[22:23], v[54:55], v[54:55]
    buffer_load_dwordx4 v[144:147], v2, s[20:23], s39 offen offset:2048 sc1
    v_pk_fma_f32 v[16:17], v[16:17], v[182:183], v[180:181] op_sel_hi:[1,0,0]
    v_pk_fma_f32 v[18:19], v[18:19], v[182:183], v[180:181] op_sel_hi:[1,0,0]
    v_pk_fma_f32 v[20:21], v[20:21], v[182:183], v[180:181] op_sel_hi:[1,0,0]
    v_pk_fma_f32 v[22:23], v[22:23], v[182:183], v[180:181] op_sel_hi:[1,0,0]
    v_pk_mul_f32 v[16:17], v[16:17], v[48:49]
    v_pk_mul_f32 v[18:19], v[18:19], v[50:51]
    v_pk_mul_f32 v[20:21], v[20:21], v[52:53]
    v_pk_mul_f32 v[22:23], v[22:23], v[54:55]
    buffer_load_dwordx4 v[148:151], v2, s[20:23], s39 offen offset:3072 sc1
    v_exp_f32 v16, v16
    v_exp_f32 v17, v17
    v_exp_f32 v18, v18
    v_exp_f32 v19, v19
    v_exp_f32 v20, v20
    v_exp_f32 v21, v21
    v_exp_f32 v22, v22
    v_exp_f32 v23, v23
    v_pk_fma_f32 v[56:57], v[120:121], v[104:105], v[56:57] op_sel_hi:[0,1,1] neg_lo:[1,0,0] neg_hi:[1,0,0]
    v_pk_fma_f32 v[58:59], v[120:121], v[106:107], v[58:59] op_sel_hi:[0,1,1] neg_lo:[1,0,0] neg_hi:[1,0,0]
    v_pk_fma_f32 v[60:61], v[120:121], v[108:109], v[60:61] op_sel_hi:[0,1,1] neg_lo:[1,0,0] neg_hi:[1,0,0]
    v_pk_fma_f32 v[62:63], v[120:121], v[110:111], v[62:63] op_sel_hi:[0,1,1] neg_lo:[1,0,0] neg_hi:[1,0,0]
    v_pk_fma_f32 v[16:17], v[16:17], v[122:123], v[122:123] op_sel_hi:[1,0,0]
    v_pk_fma_f32 v[18:19], v[18:19], v[122:123], v[122:123] op_sel_hi:[1,0,0]
    v_pk_fma_f32 v[20:21], v[20:21], v[122:123], v[122:123] op_sel_hi:[1,0,0]
    v_pk_fma_f32 v[22:23], v[22:23], v[122:123], v[122:123] op_sel_hi:[1,0,0]
    v_rcp_f32 v16, v16
    v_rcp_f32 v17, v17
    v_rcp_f32 v18, v18
    v_rcp_f32 v19, v19
    v_rcp_f32 v20, v20
    v_rcp_f32 v21, v21
    v_rcp_f32 v22, v22
    v_rcp_f32 v23, v23
    v_pk_mul_f32 v[48:49], v[48:49], v[56:57]
    v_pk_mul_f32 v[50:51], v[50:51], v[58:59]
    v_pk_mul_f32 v[52:53], v[52:53], v[60:61]
    v_pk_mul_f32 v[54:55], v[54:55], v[62:63]
    v_pk_mul_f32 v[48:49], v[48:49], v[16:17]
    v_pk_mul_f32 v[50:51], v[50:51], v[18:19]
    v_pk_mul_f32 v[52:53], v[52:53], v[20:21]
    v_pk_mul_f32 v[54:55], v[54:55], v[22:23]
    v_cvt_pk_bf16_f32 v56, v48, v49
    v_cvt_pk_bf16_f32 v57, v50, v51
    v_cvt_pk_bf16_f32 v58, v52, v53
    v_cvt_pk_bf16_f32 v59, v54, v55
    buffer_store_dwordx4 v[56:59], v2, s[20:23], s62 offen offset:1024 sc1
    v_pk_fma_f32 v[64:65], v[124:125], v[96:97], v[64:65] op_sel_hi:[0,1,1] neg_lo:[1,0,0] neg_hi:[1,0,0]
    v_pk_fma_f32 v[66:67], v[124:125], v[98:99], v[66:67] op_sel_hi:[0,1,1] neg_lo:[1,0,0] neg_hi:[1,0,0]
    v_pk_fma_f32 v[68:69], v[124:125], v[100:101], v[68:69] op_sel_hi:[0,1,1] neg_lo:[1,0,0] neg_hi:[1,0,0]
    v_pk_fma_f32 v[70:71], v[124:125], v[102:103], v[70:71] op_sel_hi:[0,1,1] neg_lo:[1,0,0] neg_hi:[1,0,0]
    v_pk_mul_f32 v[8:9], v[64:65], v[64:65]
    v_pk_mul_f32 v[10:11], v[66:67], v[66:67]
    v_pk_mul_f32 v[12:13], v[68:69], v[68:69]
    v_pk_mul_f32 v[14:15], v[70:71], v[70:71]
    buffer_load_dwordx4 v[152:155], v3, s[20:23], s39 offen sc1
    v_pk_fma_f32 v[8:9], v[8:9], v[186:187], v[184:185] op_sel_hi:[1,0,0]
    v_pk_fma_f32 v[10:11], v[10:11], v[186:187], v[184:185] op_sel_hi:[1,0,0]
    v_pk_fma_f32 v[12:13], v[12:13], v[186:187], v[184:185] op_sel_hi:[1,0,0]
    v_pk_fma_f32 v[14:15], v[14:15], v[186:187], v[184:185] op_sel_hi:[1,0,0]
    v_pk_mul_f32 v[8:9], v[8:9], v[64:65]
    v_pk_mul_f32 v[10:11], v[10:11], v[66:67]
    v_pk_mul_f32 v[12:13], v[12:13], v[68:69]
    v_pk_mul_f32 v[14:15], v[14:15], v[70:71]
    v_exp_f32 v8, v8
    v_exp_f32 v9, v9
    v_exp_f32 v10, v10
    v_exp_f32 v11, v11
    v_exp_f32 v12, v12
    v_exp_f32 v13, v13
    v_exp_f32 v14, v14
    v_exp_f32 v15, v15
    v_pk_fma_f32 v[72:73], v[124:125], v[104:105], v[72:73] op_sel_hi:[0,1,1] neg_lo:[1,0,0] neg_hi:[1,0,0]
    v_pk_fma_f32 v[74:75], v[124:125], v[106:107], v[74:75] op_sel_hi:[0,1,1] neg_lo:[1,0,0] neg_hi:[1,0,0]
    v_pk_fma_f32 v[76:77], v[124:125], v[108:109], v[76:77] op_sel_hi:[0,1,1] neg_lo:[1,0,0] neg_hi:[1,0,0]
    v_pk_fma_f32 v[78:79], v[124:125], v[110:111], v[78:79] op_sel_hi:[0,1,1] neg_lo:[1,0,0] neg_hi:[1,0,0]
    v_pk_fma_f32 v[8:9], v[8:9], v[126:127], v[126:127] op_sel_hi:[1,0,0]
    v_pk_fma_f32 v[10:11], v[10:11], v[126:127], v[126:127] op_sel_hi:[1,0,0]
    v_pk_fma_f32 v[12:13], v[12:13], v[126:127], v[126:127] op_sel_hi:[1,0,0]
    v_pk_fma_f32 v[14:15], v[14:15], v[126:127], v[126:127] op_sel_hi:[1,0,0]
    v_rcp_f32 v8, v8
    v_rcp_f32 v9, v9
    v_rcp_f32 v10, v10
    v_rcp_f32 v11, v11
    v_rcp_f32 v12, v12
    v_rcp_f32 v13, v13
    v_rcp_f32 v14, v14
    v_rcp_f32 v15, v15
    v_pk_mul_f32 v[64:65], v[64:65], v[72:73]
    v_pk_mul_f32 v[66:67], v[66:67], v[74:75]
    v_pk_mul_f32 v[68:69], v[68:69], v[76:77]
    v_pk_mul_f32 v[70:71], v[70:71], v[78:79]
    v_pk_mul_f32 v[64:65], v[64:65], v[8:9]
    v_pk_mul_f32 v[66:67], v[66:67], v[10:11]
    v_pk_mul_f32 v[68:69], v[68:69], v[12:13]
    v_pk_mul_f32 v[70:71], v[70:71], v[14:15]
    v_cvt_pk_bf16_f32 v72, v64, v65
    v_cvt_pk_bf16_f32 v73, v66, v67
    v_cvt_pk_bf16_f32 v74, v68, v69
    v_cvt_pk_bf16_f32 v75, v70, v71
    buffer_store_dwordx4 v[72:75], v2, s[20:23], s63 offen offset:0 sc1
    s_setprio 0
    v_pk_fma_f32 v[80:81], v[128:129], v[96:97], v[80:81] op_sel_hi:[0,1,1] neg_lo:[1,0,0] neg_hi:[1,0,0]
    v_pk_fma_f32 v[82:83], v[128:129], v[98:99], v[82:83] op_sel_hi:[0,1,1] neg_lo:[1,0,0] neg_hi:[1,0,0]
    v_pk_fma_f32 v[84:85], v[128:129], v[100:101], v[84:85] op_sel_hi:[0,1,1] neg_lo:[1,0,0] neg_hi:[1,0,0]
    v_pk_fma_f32 v[86:87], v[128:129], v[102:103], v[86:87] op_sel_hi:[0,1,1] neg_lo:[1,0,0] neg_hi:[1,0,0]
    v_pk_mul_f32 v[16:17], v[80:81], v[80:81]
    v_pk_mul_f32 v[18:19], v[82:83], v[82:83]
    v_pk_mul_f32 v[20:21], v[84:85], v[84:85]
    v_pk_mul_f32 v[22:23], v[86:87], v[86:87]
    v_pk_fma_f32 v[16:17], v[16:17], v[190:191], v[188:189] op_sel_hi:[1,0,0]
    v_pk_fma_f32 v[18:19], v[18:19], v[190:191], v[188:189] op_sel_hi:[1,0,0]
    v_pk_fma_f32 v[20:21], v[20:21], v[190:191], v[188:189] op_sel_hi:[1,0,0]
    v_pk_fma_f32 v[22:23], v[22:23], v[190:191], v[188:189] op_sel_hi:[1,0,0]
    v_pk_mul_f32 v[16:17], v[16:17], v[80:81]
    v_pk_mul_f32 v[18:19], v[18:19], v[82:83]
    v_pk_mul_f32 v[20:21], v[20:21], v[84:85]
    v_pk_mul_f32 v[22:23], v[22:23], v[86:87]
    v_exp_f32 v16, v16
    v_exp_f32 v17, v17
    v_exp_f32 v18, v18
    v_exp_f32 v19, v19
    v_exp_f32 v20, v20
    v_exp_f32 v21, v21
    v_exp_f32 v22, v22
    v_exp_f32 v23, v23
    v_pk_fma_f32 v[88:89], v[128:129], v[104:105], v[88:89] op_sel_hi:[0,1,1] neg_lo:[1,0,0] neg_hi:[1,0,0]
    v_pk_fma_f32 v[90:91], v[128:129], v[106:107], v[90:91] op_sel_hi:[0,1,1] neg_lo:[1,0,0] neg_hi:[1,0,0]
    v_pk_fma_f32 v[92:93], v[128:129], v[108:109], v[92:93] op_sel_hi:[0,1,1] neg_lo:[1,0,0] neg_hi:[1,0,0]
    v_pk_fma_f32 v[94:95], v[128:129], v[110:111], v[94:95] op_sel_hi:[0,1,1] neg_lo:[1,0,0] neg_hi:[1,0,0]
    v_pk_fma_f32 v[16:17], v[16:17], v[130:131], v[130:131] op_sel_hi:[1,0,0]
    v_pk_fma_f32 v[18:19], v[18:19], v[130:131], v[130:131] op_sel_hi:[1,0,0]
    v_pk_fma_f32 v[20:21], v[20:21], v[130:131], v[130:131] op_sel_hi:[1,0,0]
    v_pk_fma_f32 v[22:23], v[22:23], v[130:131], v[130:131] op_sel_hi:[1,0,0]
    v_rcp_f32 v16, v16
    v_rcp_f32 v17, v17
    v_rcp_f32 v18, v18
    v_rcp_f32 v19, v19
    v_rcp_f32 v20, v20
    v_rcp_f32 v21, v21
    v_rcp_f32 v22, v22
    v_rcp_f32 v23, v23
    v_pk_mul_f32 v[80:81], v[80:81], v[88:89]
    v_pk_mul_f32 v[82:83], v[82:83], v[90:91]
    v_pk_mul_f32 v[84:85], v[84:85], v[92:93]
    v_pk_mul_f32 v[86:87], v[86:87], v[94:95]
    v_pk_mul_f32 v[80:81], v[80:81], v[16:17]
    v_pk_mul_f32 v[82:83], v[82:83], v[18:19]
    v_pk_mul_f32 v[84:85], v[84:85], v[20:21]
    v_pk_mul_f32 v[86:87], v[86:87], v[22:23]
    v_cvt_pk_bf16_f32 v88, v80, v81
    v_cvt_pk_bf16_f32 v89, v82, v83
    v_cvt_pk_bf16_f32 v90, v84, v85
    v_cvt_pk_bf16_f32 v91, v86, v87
    buffer_store_dwordx4 v[88:91], v2, s[20:23], s63 offen offset:1024 sc1
    s_waitcnt vmcnt(0)
    s_branch K_seam
K_slow0F:
    s_mov_b32 s63, 0
K_slow0F_l:
    buffer_load_dwordx2 v[6:7], v4, s[76:79], 0 offen sc1
    s_add_u32 s63, s63, 1
    s_waitcnt vmcnt(0)
    v_readfirstlane_b32 s72, v6
    v_readfirstlane_b32 s73, v7
    s_cmp_gt_u32 s63, 131072
    s_cbranch_scc1 K_back0F
    s_cmp_eq_u32 s72, 0
    s_cbranch_scc1 K_slow0F_l
    s_branch K_back0F
K_slow1F:
    s_mov_b32 s63, 0
K_slow1F_l:
    s_sleep 1
    buffer_load_dwordx4 v[240:243], v30, s[20:23], s61 offen sc1
    buffer_load_dwordx4 v[244:247], v30, s[20:23], s61 offen offset:16 sc1
    s_add_u32 s63, s63, 1
    s_waitcnt vmcnt(0)
    v_cmp_ne_u64 vcc, s[72:73], v[240:241]
    v_cmp_ne_u64 s[80:81], s[72:73], v[242:243]
    v_cmp_ne_u64 s[82:83], s[72:73], v[244:245]
    v_cmp_ne_u64 s[44:45], s[72:73], v[246:247]
    s_nop 0
    s_or_b64 s[80:81], s[80:81], s[82:83]
    s_or_b64 vcc, vcc, s[44:45]
    s_or_b64 vcc, vcc, s[80:81]
    s_cmp_gt_u32 s63, 131072
    s_cbranch_scc1 K_back1F
    s_cbranch_vccnz K_slow1F_l
    s_branch K_back1F
K_slow0D:
    s_mov_b32 s63, 0
K_slow0D_l:
    buffer_load_dwordx2 v[6:7], v4, s[76:79], 0 offen sc1
    s_add_u32 s63, s63, 1
    s_waitcnt vmcnt(0)
    v_readfirstlane_b32 s72, v6
    v_readfirstlane_b32 s73, v7
    s_cmp_gt_u32 s63, 131072
    s_cbranch_scc1 K_back0D
    s_cmp_eq_u32 s72, 0
    s_cbranch_scc1 K_slow0D_l
    s_branch K_back0D
K_slow1D:
    s_mov_b32 s63, 0
K_slow1D_l:
    s_sleep 1
    buffer_load_dwordx4 v[240:243], v30, s[20:23], s61 offen sc1
    buffer_load_dwordx4 v[244:247], v30, s[20:23], s61 offen offset:16 sc1
    s_add_u32 s63, s63, 1
    s_waitcnt vmcnt(0)
    v_cmp_ne_u64 vcc, s[72:73], v[240:241]
    v_cmp_ne_u64 s[80:81], s[72:73], v[242:243]
    v_cmp_ne_u64 s[82:83], s[72:73], v[244:245]
    v_cmp_ne_u64 s[44:45], s[72:73], v[246:247]
    s_nop 0
    s_or_b64 s[80:81], s[80:81], s[82:83]
    s_or_b64 vcc, vcc, s[44:45]
    s_or_b64 vcc, vcc, s[80:81]
    s_cmp_gt_u32 s63, 131072
    s_cbranch_scc1 K_back1D
    s_cbranch_vccnz K_slow1D_l
    s_branch K_back1D
K_loopD:
    ds_read_b64_tr_b16 v[148:149], v12 offset:0
    ds_read_b64_tr_b16 v[150:151], v12 offset:512
    ds_read_b64_tr_b16 v[152:153], v12 offset:8192
    ds_read_b64_tr_b16 v[154:155], v12 offset:8704
    ds_read_b128 v[116:119], v8 offset:0
    ds_read_b128 v[120:123], v8 offset:2048
    ds_read_b128 v[124:127], v8 offset:4096
    ds_read_b128 v[128:131], v8 offset:6144
    ds_read_b128 v[132:135], v8 offset:8192
    ds_read_b128 v[136:139], v8 offset:10240
    ds_read_b128 v[140:143], v8 offset:12288
    ds_read_b128 v[144:147], v8 offset:14336
    s_waitcnt lgkmcnt(0)
    v_cndmask_b32 v152, v152, v25, s[70:71]
    v_cndmask_b32 v153, v153, v25, s[70:71]
    v_cndmask_b32 v154, v154, v25, s[70:71]
    v_cndmask_b32 v155, v155, v25, s[70:71]
    s_add_u32 m0, s37, 49152
    v_mfma_f32_16x16x32_bf16 v[32:35], v[116:119], v[148:151], 0
    ds_read_b64_tr_b16 v[188:189], v14 offset:0
    buffer_load_dwordx4 v24, s[12:15], s34 offen lds
    s_mul_i32 s42, s28, 7
    s_cmp_eq_u32 s28, 7
    s_cselect_b32 s42, 48, s42
    s_mul_i32 s43, s41, 54
    v_mfma_f32_16x16x32_bf16 v[40:43], v[120:123], v[148:151], 0
    ds_read_b64_tr_b16 v[190:191], v14 offset:512
    s_add_u32 s43, s43, s42
    s_mul_i32 s43, s43, 5120
    s_add_u32 m0, s37, 57344
    v_mfma_f32_16x16x32_bf16 v[48:51], v[124:127], v[148:151], 0
    ds_read_b64_tr_b16 v[192:193], v14 offset:8192
    buffer_load_dwordx4 v24, s[16:19], s34 offen lds
    s_add_u32 s43, s43, 8388608
    s_mul_i32 s54, s40, 54
    s_add_u32 s42, s42, s54
    v_mfma_f32_16x16x32_bf16 v[56:59], v[128:131], v[148:151], 0
    ds_read_b64_tr_b16 v[194:195], v14 offset:8704
    s_lshl_b32 s42, s42, 12
    s_lshr_b32 s54, s29, 2
    v_mfma_f32_16x16x32_bf16 v[64:67], v[132:135], v[148:151], 0
    ds_read_b128 v[156:159], v9 offset:0
    s_add_u32 s54, s54, s29
    s_lshr_b32 s61, s55, 1
    s_add_u32 s54, s54, s61
    s_lshl_b32 s33, s32, 7
    s_mul_i32 s34, s32, s35
    s_add_u32 s32, s32, 1
    s_cmp_eq_u32 s32, 10
    s_cselect_b32 s32, 0, s32
    s_add_u32 m0, s36, 98304
    v_mfma_f32_16x16x32_bf16 v[72:75], v[136:139], v[148:151], 0
    ds_read_b128 v[160:163], v9 offset:2048
    buffer_load_dwordx4 v20, s[8:11], s33 offen lds
    s_lshl_b32 s54, s54, 1
    s_and_b32 s61, s55, 1
    v_mfma_f32_16x16x32_bf16 v[80:83], v[140:143], v[148:151], 0
    ds_read_b128 v[164:167], v9 offset:4096
    s_add_u32 s54, s54, s61
    s_mul_i32 s61, s30, 20
    s_add_u32 s54, s54, s61
    s_add_u32 m0, s36, 99328
    v_mfma_f32_16x16x32_bf16 v[88:91], v[144:147], v[148:151], 0
    ds_read_b128 v[168:171], v9 offset:6144
    buffer_load_dwordx4 v21, s[8:11], s33 offen lds
    s_lshl_b32 s54, s54, 9
    s_lshl_b32 s61, s56, 8
    v_mfma_f32_16x16x32_bf16 v[92:95], v[144:147], v[152:155], 0
    ds_read_b128 v[172:175], v9 offset:8192
    s_add_u32 s54, s54, s61
    s_add_u32 s69, s54, 15990784
    s_and_b32 s54, s29, 3
    v_mfma_f32_16x16x32_bf16 v[84:87], v[140:143], v[152:155], 0
    ds_read_b128 v[176:179], v9 offset:10240
    s_cmp_eq_u32 s54, 3
    s_cselect_b32 s49, 1, 0
    s_cmp_ge_u32 s55, 2
    s_cselect_b32 s74, s49, 0
    s_cselect_b32 s49, s49, 1
    s_add_u32 m0, s3, 100352
    v_mfma_f32_16x16x32_bf16 v[76:79], v[136:139], v[152:155], 0
    ds_read_b128 v[180:183], v9 offset:12288
    buffer_load_dwordx4 v22, s[8:11], s33 offen lds
    s_lshl_b32 s68, s29, 5
    s_add_u32 s68, s68, s30
    s_lshl_b32 s38, s68, 3
    v_mfma_f32_16x16x32_bf16 v[68:71], v[132:135], v[152:155], 0
    ds_read_b128 v[184:187], v9 offset:14336
    s_add_u32 s48, s38, 15794176
    s_lshl_b32 s68, s68, 8
    s_add_u32 m0, s3, 101376
    v_mfma_f32_16x16x32_bf16 v[60:63], v[128:131], v[152:155], 0
    buffer_load_dwordx4 v23, s[8:11], s33 offen lds
    s_add_u32 s68, s68, 15798272
    s_lshl_b32 s54, s29, 12
    s_lshl_b32 s61, s62, 4
    v_mfma_f32_16x16x32_bf16 v[52:55], v[124:127], v[152:155], 0
    s_add_u32 s54, s54, s61
    s_add_u32 s38, s54, 15761408
    v_mfma_f32_16x16x32_bf16 v[44:47], v[120:123], v[152:155], 0
    v_cmp_eq_u32 vcc, 0, v1
    v_mov_b32 v254, 2146435072
    v_mov_b32 v255, 986500301
    v_cndmask_b32 v254, v254, 0, vcc
    v_mfma_f32_16x16x32_bf16 v[36:39], v[116:119], v[152:155], 0
    v_add_u32 v3, 4096, v2
    v_mov_b32 v4, 0
    v_lshlrev_b32 v30, 2, v1
    v_mov_b32 v5, 0
    s_waitcnt lgkmcnt(0)
    v_cndmask_b32 v192, v192, v25, s[70:71]
    v_cndmask_b32 v193, v193, v25, s[70:71]
    v_cndmask_b32 v194, v194, v25, s[70:71]
    v_cndmask_b32 v195, v195, v25, s[70:71]
    s_add_u32 m0, s37, 98304
    v_mfma_f32_16x16x32_bf16 v[32:35], v[156:159], v[188:191], v[32:35]
    buffer_load_dwordx4 v24, s[12:15], s34 offen lds
    v_mfma_f32_16x16x32_bf16 v[40:43], v[160:163], v[188:191], v[40:43]
    v_mfma_f32_16x16x32_bf16 v[48:51], v[164:167], v[188:191], v[48:51]
    s_add_u32 m0, s37, 106496
    s_nop 0
    buffer_load_dwordx4 v24, s[16:19], s34 offen lds
    s_waitcnt vmcnt(6)
    s_barrier
    ds_read_b64_tr_b16 v[148:149], v12 offset:49152
    v_mfma_f32_16x16x32_bf16 v[56:59], v[168:171], v[188:191], v[56:59]
    ds_read_b64_tr_b16 v[150:151], v12 offset:49664
    v_mfma_f32_16x16x32_bf16 v[64:67], v[172:175], v[188:191], v[64:67]
    ds_read_b64_tr_b16 v[152:153], v12 offset:57344
    v_lshlrev_b32 v236, 16, v206
    v_and_b32 v237, 0xffff0000, v206
    v_mfma_f32_16x16x32_bf16 v[72:75], v[176:179], v[188:191], v[72:75]
    ds_read_b64_tr_b16 v[154:155], v12 offset:57856
    v_lshlrev_b32 v238, 16, v207
    v_and_b32 v239, 0xffff0000, v207
    v_mfma_f32_16x16x32_bf16 v[80:83], v[180:183], v[188:191], v[80:83]
    ds_read_b128 v[116:119], v8 offset:49152
    v_lshlrev_b32 v240, 16, v208
    v_and_b32 v241, 0xffff0000, v208
    v_mfma_f32_16x16x32_bf16 v[88:91], v[184:187], v[188:191], v[88:91]
    ds_read_b128 v[120:123], v8 offset:51200
    v_lshlrev_b32 v242, 16, v209
    v_and_b32 v243, 0xffff0000, v209
    v_mfma_f32_16x16x32_bf16 v[92:95], v[184:187], v[192:195], v[92:95]
    ds_read_b128 v[124:127], v8 offset:53248
    v_lshlrev_b32 v244, 16, v210
    v_and_b32 v245, 0xffff0000, v210
    v_mfma_f32_16x16x32_bf16 v[84:87], v[180:183], v[192:195], v[84:87]
    ds_read_b128 v[128:131], v8 offset:55296
    v_add_f32 v246, v236, v237
    v_add_f32 v247, v238, v239
    v_mfma_f32_16x16x32_bf16 v[76:79], v[176:179], v[192:195], v[76:79]
    ds_read_b128 v[132:135], v8 offset:57344
    v_add_f32 v246, v246, v240
    v_add_f32 v247, v247, v241
    s_lshl_b32 s33, s32, 7
    s_mul_i32 s34, s32, s35
    s_add_u32 s32, s32, 1
    s_cmp_eq_u32 s32, 10
    s_cselect_b32 s32, 0, s32
    s_add_u32 m0, s36, 0
    v_mfma_f32_16x16x32_bf16 v[68:71], v[172:175], v[192:195], v[68:71]
    ds_read_b128 v[136:139], v8 offset:59392
    buffer_load_dwordx4 v20, s[8:11], s33 offen lds
    v_add_f32 v246, v246, v242
    v_add_f32 v247, v247, v243
    v_mfma_f32_16x16x32_bf16 v[60:63], v[168:171], v[192:195], v[60:63]
    ds_read_b128 v[140:143], v8 offset:61440
    v_add_f32 v246, v246, v244
    v_add_f32 v247, v247, v245
    v_mfma_f32_16x16x32_bf16 v[52:55], v[164:167], v[192:195], v[52:55]
    ds_read_b128 v[144:147], v8 offset:63488
    v_add_f32 v246, v246, v247
    s_add_u32 m0, s36, 1024
    v_mfma_f32_16x16x32_bf16 v[44:47], v[160:163], v[192:195], v[44:47]
    buffer_load_dwordx4 v21, s[8:11], s33 offen lds
    s_nop 0
    v_add_f32_dpp v246, v246, v246 row_shr:1 row_mask:0xf bank_mask:0xf bound_ctrl:0
    v_mfma_f32_16x16x32_bf16 v[36:39], v[156:159], v[192:195], v[36:39]
    s_nop 0
    v_add_f32_dpp v246, v246, v246 row_shr:2 row_mask:0xf bank_mask:0xf bound_ctrl:0
    s_waitcnt lgkmcnt(0)
    v_cndmask_b32 v152, v152, v25, s[70:71]
    v_cndmask_b32 v153, v153, v25, s[70:71]
    v_cndmask_b32 v154, v154, v25, s[70:71]
    v_cndmask_b32 v155, v155, v25, s[70:71]
    v_mfma_f32_16x16x32_bf16 v[32:35], v[116:119], v[148:151], v[32:35]
    ds_read_b64_tr_b16 v[188:189], v14 offset:49152
    s_nop 0
    v_add_f32_dpp v246, v246, v246 row_shr:4 row_mask:0xf bank_mask:0xf bound_ctrl:0
    v_mfma_f32_16x16x32_bf16 v[40:43], v[120:123], v[148:151], v[40:43]
    ds_read_b64_tr_b16 v[190:191], v14 offset:49664
    s_nop 0
    v_add_f32_dpp v246, v246, v246 row_shr:8 row_mask:0xf bank_mask:0xf bound_ctrl:0
    v_mfma_f32_16x16x32_bf16 v[48:51], v[124:127], v[148:151], v[48:51]
    ds_read_b64_tr_b16 v[192:193], v14 offset:57344
    s_nop 0
    v_add_f32_dpp v246, v246, v246 row_bcast:15 row_mask:0xa bank_mask:0xf
    s_add_u32 m0, s3, 2048
    v_mfma_f32_16x16x32_bf16 v[56:59], v[128:131], v[148:151], v[56:59]
    ds_read_b64_tr_b16 v[194:195], v14 offset:57856
    buffer_load_dwordx4 v22, s[8:11], s33 offen lds
    s_nop 0
    v_add_f32_dpp v246, v246, v246 row_bcast:31 row_mask:0xc bank_mask:0xf
    v_mfma_f32_16x16x32_bf16 v[64:67], v[132:135], v[148:151], v[64:67]
    ds_read_b128 v[156:159], v9 offset:49152
    v_readlane_b32 s60, v246, 63
    v_mfma_f32_16x16x32_bf16 v[72:75], v[136:139], v[148:151], v[72:75]
    ds_read_b128 v[160:163], v9 offset:51200
    s_nop 0
    v_mul_f32 v248, s60, v255
    v_sub_f32 v236, v236, v248
    v_mfma_f32_16x16x32_bf16 v[80:83], v[140:143], v[148:151], v[80:83]
    ds_read_b128 v[164:167], v9 offset:53248
    buffer_load_dwordx2 v[6:7], v4, s[76:79], 0 offen sc1
    v_sub_f32 v237, v237, v248
    v_sub_f32 v238, v238, v248
    v_mfma_f32_16x16x32_bf16 v[88:91], v[144:147], v[148:151], v[88:91]
    ds_read_b128 v[168:171], v9 offset:55296
    v_sub_f32 v239, v239, v248
    v_sub_f32 v240, v240, v248
    s_add_u32 m0, s3, 3072
    v_mfma_f32_16x16x32_bf16 v[92:95], v[144:147], v[152:155], v[92:95]
    ds_read_b128 v[172:175], v9 offset:57344
    buffer_load_dwordx4 v23, s[8:11], s33 offen lds
    v_sub_f32 v241, v241, v248
    v_sub_f32 v242, v242, v248
    v_mfma_f32_16x16x32_bf16 v[84:87], v[140:143], v[152:155], v[84:87]
    ds_read_b128 v[176:179], v9 offset:59392
    v_sub_f32 v243, v243, v248
    v_sub_f32 v244, v244, v248
    v_mfma_f32_16x16x32_bf16 v[76:79], v[136:139], v[152:155], v[76:79]
    ds_read_b128 v[180:183], v9 offset:61440
    v_sub_f32 v245, v245, v248
    v_mul_f32 v246, v236, v236
    v_mfma_f32_16x16x32_bf16 v[68:71], v[132:135], v[152:155], v[68:71]
    ds_read_b128 v[184:187], v9 offset:63488
    v_mul_f32 v247, v237, v237
    v_fmac_f32 v246, v238, v238
    v_mfma_f32_16x16x32_bf16 v[60:63], v[128:131], v[152:155], v[60:63]
    v_fmac_f32 v247, v239, v239
    v_fmac_f32 v246, v240, v240
    s_add_u32 m0, s37, 0
    v_mfma_f32_16x16x32_bf16 v[52:55], v[124:127], v[152:155], v[52:55]
    buffer_load_dwordx4 v24, s[12:15], s34 offen lds
    v_fmac_f32 v247, v241, v241
    v_fmac_f32 v246, v242, v242
    v_mfma_f32_16x16x32_bf16 v[44:47], v[120:123], v[152:155], v[44:47]
    v_fmac_f32 v247, v243, v243
    v_fmac_f32 v246, v244, v244
    v_mfma_f32_16x16x32_bf16 v[36:39], v[116:119], v[152:155], v[36:39]
    v_fmac_f32 v247, v245, v245
    v_add_f32 v246, v246, v247
    s_waitcnt lgkmcnt(0)
    v_cndmask_b32 v192, v192, v25, s[70:71]
    v_cndmask_b32 v193, v193, v25, s[70:71]
    v_cndmask_b32 v194, v194, v25, s[70:71]
    v_cndmask_b32 v195, v195, v25, s[70:71]
    v_mfma_f32_16x16x32_bf16 v[32:35], v[156:159], v[188:191], v[32:35]
    s_nop 0
    v_add_f32_dpp v246, v246, v246 row_shr:1 row_mask:0xf bank_mask:0xf bound_ctrl:0
    s_add_u32 m0, s37, 8192
    v_mfma_f32_16x16x32_bf16 v[40:43], v[160:163], v[188:191], v[40:43]
    buffer_load_dwordx4 v24, s[16:19], s34 offen lds
    s_nop 0
    v_add_f32_dpp v246, v246, v246 row_shr:2 row_mask:0xf bank_mask:0xf bound_ctrl:0
    v_mfma_f32_16x16x32_bf16 v[48:51], v[164:167], v[188:191], v[48:51]
    s_waitcnt vmcnt(7)
    s_barrier
    ds_read_b64_tr_b16 v[148:149], v16 offset:0
    s_nop 0
    v_add_f32_dpp v246, v246, v246 row_shr:4 row_mask:0xf bank_mask:0xf bound_ctrl:0
    v_mfma_f32_16x16x32_bf16 v[56:59], v[168:171], v[188:191], v[56:59]
    ds_read_b64_tr_b16 v[150:151], v16 offset:512
    s_nop 0
    v_add_f32_dpp v246, v246, v246 row_shr:8 row_mask:0xf bank_mask:0xf bound_ctrl:0
    v_mfma_f32_16x16x32_bf16 v[64:67], v[172:175], v[188:191], v[64:67]
    ds_read_b64_tr_b16 v[152:153], v16 offset:8192
    s_nop 0
    v_add_f32_dpp v246, v246, v246 row_bcast:15 row_mask:0xa bank_mask:0xf
    v_mfma_f32_16x16x32_bf16 v[72:75], v[176:179], v[188:191], v[72:75]
    ds_read_b64_tr_b16 v[154:155], v16 offset:8704
    s_nop 0
    v_add_f32_dpp v246, v246, v246 row_bcast:31 row_mask:0xc bank_mask:0xf
    v_mfma_f32_16x16x32_bf16 v[80:83], v[180:183], v[188:191], v[80:83]
    ds_read_b128 v[116:119], v10 offset:0
    v_readlane_b32 s60, v246, 63
    v_mfma_f32_16x16x32_bf16 v[88:91], v[184:187], v[188:191], v[88:91]
    ds_read_b128 v[120:123], v10 offset:2048
    v_mov_b32 v250, 925353388
    v_fma_f32 v250, s60, v255, v250
    v_rsq_f32 v249, v250
    v_mfma_f32_16x16x32_bf16 v[92:95], v[184:187], v[192:195], v[92:95]
    ds_read_b128 v[124:127], v10 offset:4096
    buffer_store_dwordx3 v[248:250], v254, s[20:23], s38 offen sc1
    v_mfma_f32_16x16x32_bf16 v[84:87], v[180:183], v[192:195], v[84:87]
    ds_read_b128 v[128:131], v10 offset:6144
    v_mfma_f32_16x16x32_bf16 v[76:79], v[176:179], v[192:195], v[76:79]
    ds_read_b128 v[132:135], v10 offset:8192
    s_lshl_b32 s33, s32, 7
    s_mul_i32 s34, s32, s35
    s_add_u32 s32, s32, 1
    s_cmp_eq_u32 s32, 10
    s_cselect_b32 s32, 0, s32
    s_add_u32 m0, s36, 49152
    v_mfma_f32_16x16x32_bf16 v[68:71], v[172:175], v[192:195], v[68:71]
    ds_read_b128 v[136:139], v10 offset:10240
    buffer_load_dwordx4 v20, s[8:11], s33 offen lds
    v_mfma_f32_16x16x32_bf16 v[60:63], v[168:171], v[192:195], v[60:63]
    ds_read_b128 v[140:143], v10 offset:12288
    v_mfma_f32_16x16x32_bf16 v[52:55], v[164:167], v[192:195], v[52:55]
    ds_read_b128 v[144:147], v10 offset:14336
    s_add_u32 m0, s36, 50176
    v_mfma_f32_16x16x32_bf16 v[44:47], v[160:163], v[192:195], v[44:47]
    buffer_load_dwordx4 v21, s[8:11], s33 offen lds
    v_mfma_f32_16x16x32_bf16 v[36:39], v[156:159], v[192:195], v[36:39]
    s_waitcnt lgkmcnt(0)
    v_cndmask_b32 v152, v152, v25, s[70:71]
    v_cndmask_b32 v153, v153, v25, s[70:71]
    v_cndmask_b32 v154, v154, v25, s[70:71]
    v_cndmask_b32 v155, v155, v25, s[70:71]
    v_mfma_f32_16x16x32_bf16 v[32:35], v[116:119], v[148:151], v[32:35]
    ds_read_b64_tr_b16 v[188:189], v18 offset:0
    v_mfma_f32_16x16x32_bf16 v[40:43], v[120:123], v[148:151], v[40:43]
    ds_read_b64_tr_b16 v[190:191], v18 offset:512
    v_mfma_f32_16x16x32_bf16 v[48:51], v[124:127], v[148:151], v[48:51]
    ds_read_b64_tr_b16 v[192:193], v18 offset:8192
    s_add_u32 m0, s3, 51200
    v_mfma_f32_16x16x32_bf16 v[56:59], v[128:131], v[148:151], v[56:59]
    ds_read_b64_tr_b16 v[194:195], v18 offset:8704
    buffer_load_dwordx4 v22, s[8:11], s33 offen lds
    v_mfma_f32_16x16x32_bf16 v[64:67], v[132:135], v[148:151], v[64:67]
    ds_read_b128 v[156:159], v11 offset:0
    v_mfma_f32_16x16x32_bf16 v[72:75], v[136:139], v[148:151], v[72:75]
    ds_read_b128 v[160:163], v11 offset:2048
    v_mfma_f32_16x16x32_bf16 v[80:83], v[140:143], v[148:151], v[80:83]
    ds_read_b128 v[164:167], v11 offset:4096
    v_mfma_f32_16x16x32_bf16 v[88:91], v[144:147], v[148:151], v[88:91]
    ds_read_b128 v[168:171], v11 offset:6144
    s_add_u32 m0, s3, 52224
    v_mfma_f32_16x16x32_bf16 v[92:95], v[144:147], v[152:155], v[92:95]
    ds_read_b128 v[172:175], v11 offset:8192
    buffer_load_dwordx4 v23, s[8:11], s33 offen lds
    v_mfma_f32_16x16x32_bf16 v[84:87], v[140:143], v[152:155], v[84:87]
    ds_read_b128 v[176:179], v11 offset:10240
    v_mfma_f32_16x16x32_bf16 v[76:79], v[136:139], v[152:155], v[76:79]
    ds_read_b128 v[180:183], v11 offset:12288
    v_mfma_f32_16x16x32_bf16 v[68:71], v[132:135], v[152:155], v[68:71]
    ds_read_b128 v[184:187], v11 offset:14336
    v_mfma_f32_16x16x32_bf16 v[60:63], v[128:131], v[152:155], v[60:63]
    s_add_u32 m0, s37, 49152
    v_mfma_f32_16x16x32_bf16 v[52:55], v[124:127], v[152:155], v[52:55]
    buffer_load_dwordx4 v24, s[12:15], s34 offen lds
    v_mfma_f32_16x16x32_bf16 v[44:47], v[120:123], v[152:155], v[44:47]
    v_mfma_f32_16x16x32_bf16 v[36:39], v[116:119], v[152:155], v[36:39]
    s_waitcnt lgkmcnt(0)
    v_cndmask_b32 v192, v192, v25, s[70:71]
    v_cndmask_b32 v193, v193, v25, s[70:71]
    v_cndmask_b32 v194, v194, v25, s[70:71]
    v_cndmask_b32 v195, v195, v25, s[70:71]
    v_mfma_f32_16x16x32_bf16 v[32:35], v[156:159], v[188:191], v[32:35]
    s_add_u32 m0, s37, 57344
    v_mfma_f32_16x16x32_bf16 v[40:43], v[160:163], v[188:191], v[40:43]
    buffer_load_dwordx4 v24, s[16:19], s34 offen lds
    v_mfma_f32_16x16x32_bf16 v[48:51], v[164:167], v[188:191], v[48:51]
    s_waitcnt vmcnt(7)
    s_barrier
    ds_read_b64_tr_b16 v[148:149], v12 offset:0
    v_mfma_f32_16x16x32_bf16 v[56:59], v[168:171], v[188:191], v[56:59]
    ds_read_b64_tr_b16 v[150:151], v12 offset:512
    v_mfma_f32_16x16x32_bf16 v[64:67], v[172:175], v[188:191], v[64:67]
    ds_read_b64_tr_b16 v[152:153], v12 offset:8192
    v_mfma_f32_16x16x32_bf16 v[72:75], v[176:179], v[188:191], v[72:75]
    ds_read_b64_tr_b16 v[154:155], v12 offset:8704
    v_mfma_f32_16x16x32_bf16 v[80:83], v[180:183], v[188:191], v[80:83]
    ds_read_b128 v[116:119], v8 offset:0
    v_mfma_f32_16x16x32_bf16 v[88:91], v[184:187], v[188:191], v[88:91]
    ds_read_b128 v[120:123], v8 offset:2048
    v_mfma_f32_16x16x32_bf16 v[92:95], v[184:187], v[192:195], v[92:95]
    ds_read_b128 v[124:127], v8 offset:4096
    v_mfma_f32_16x16x32_bf16 v[84:87], v[180:183], v[192:195], v[84:87]
    ds_read_b128 v[128:131], v8 offset:6144
    v_readfirstlane_b32 s72, v6
    v_readfirstlane_b32 s73, v7
    s_nop 0
    s_cmp_eq_u32 s72, 0
    s_cbranch_scc1 K_slow0D
K_back0D:
    v_mfma_f32_16x16x32_bf16 v[76:79], v[176:179], v[192:195], v[76:79]
    ds_read_b128 v[132:135], v8 offset:8192
    s_lshl_b32 s33, s32, 7
    s_mul_i32 s34, s32, s35
    s_add_u32 s32, s32, 1
    s_cmp_eq_u32 s32, 10
    s_cselect_b32 s32, 0, s32
    s_add_u32 m0, s36, 98304
    v_mfma_f32_16x16x32_bf16 v[68:71], v[172:175], v[192:195], v[68:71]
    ds_read_b128 v[136:139], v8 offset:10240
    buffer_load_dwordx4 v20, s[8:11], s33 offen lds
    v_mfma_f32_16x16x32_bf16 v[60:63], v[168:171], v[192:195], v[60:63]
    ds_read_b128 v[140:143], v8 offset:12288
    v_mfma_f32_16x16x32_bf16 v[52:55], v[164:167], v[192:195], v[52:55]
    ds_read_b128 v[144:147], v8 offset:14336
    s_add_u32 m0, s36, 99328
    v_mfma_f32_16x16x32_bf16 v[44:47], v[160:163], v[192:195], v[44:47]
    buffer_load_dwordx4 v21, s[8:11], s33 offen lds
    v_mfma_f32_16x16x32_bf16 v[36:39], v[156:159], v[192:195], v[36:39]
    s_waitcnt lgkmcnt(0)
    v_cndmask_b32 v152, v152, v25, s[70:71]
    v_cndmask_b32 v153, v153, v25, s[70:71]
    v_cndmask_b32 v154, v154, v25, s[70:71]
    v_cndmask_b32 v155, v155, v25, s[70:71]
    v_mfma_f32_16x16x32_bf16 v[32:35], v[116:119], v[148:151], v[32:35]
    ds_read_b64_tr_b16 v[188:189], v14 offset:0
    v_mfma_f32_16x16x32_bf16 v[40:43], v[120:123], v[148:151], v[40:43]
    ds_read_b64_tr_b16 v[190:191], v14 offset:512
    v_mfma_f32_16x16x32_bf16 v[48:51], v[124:127], v[148:151], v[48:51]
    ds_read_b64_tr_b16 v[192:193], v14 offset:8192
    s_add_u32 m0, s3, 100352
    v_mfma_f32_16x16x32_bf16 v[56:59], v[128:131], v[148:151], v[56:59]
    ds_read_b64_tr_b16 v[194:195], v14 offset:8704
    buffer_load_dwordx4 v22, s[8:11], s33 offen lds
    v_mfma_f32_16x16x32_bf16 v[64:67], v[132:135], v[148:151], v[64:67]
    ds_read_b128 v[156:159], v9 offset:0
    v_mfma_f32_16x16x32_bf16 v[72:75], v[136:139], v[148:151], v[72:75]
    ds_read_b128 v[160:163], v9 offset:2048
    v_mfma_f32_16x16x32_bf16 v[80:83], v[140:143], v[148:151], v[80:83]
    ds_read_b128 v[164:167], v9 offset:4096
    v_mfma_f32_16x16x32_bf16 v[88:91], v[144:147], v[148:151], v[88:91]
    ds_read_b128 v[168:171], v9 offset:6144
    s_add_u32 m0, s3, 101376
    v_mfma_f32_16x16x32_bf16 v[92:95], v[144:147], v[152:155], v[92:95]
    ds_read_b128 v[172:175], v9 offset:8192
    buffer_load_dwordx4 v23, s[8:11], s33 offen lds
    v_mfma_f32_16x16x32_bf16 v[84:87], v[140:143], v[152:155], v[84:87]
    ds_read_b128 v[176:179], v9 offset:10240
    v_mfma_f32_16x16x32_bf16 v[76:79], v[136:139], v[152:155], v[76:79]
    ds_read_b128 v[180:183], v9 offset:12288
    v_mfma_f32_16x16x32_bf16 v[68:71], v[132:135], v[152:155], v[68:71]
    ds_read_b128 v[184:187], v9 offset:14336
    v_mfma_f32_16x16x32_bf16 v[60:63], v[128:131], v[152:155], v[60:63]
    s_add_u32 m0, s37, 98304
    v_mfma_f32_16x16x32_bf16 v[52:55], v[124:127], v[152:155], v[52:55]
    buffer_load_dwordx4 v24, s[12:15], s34 offen lds
    v_mfma_f32_16x16x32_bf16 v[44:47], v[120:123], v[152:155], v[44:47]
    v_mfma_f32_16x16x32_bf16 v[36:39], v[116:119], v[152:155], v[36:39]
    s_waitcnt lgkmcnt(0)
    v_cndmask_b32 v192, v192, v25, s[70:71]
    v_cndmask_b32 v193, v193, v25, s[70:71]
    v_cndmask_b32 v194, v194, v25, s[70:71]
    v_cndmask_b32 v195, v195, v25, s[70:71]
    v_mfma_f32_16x16x32_bf16 v[32:35], v[156:159], v[188:191], v[32:35]
    s_add_u32 m0, s37, 106496
    v_mfma_f32_16x16x32_bf16 v[40:43], v[160:163], v[188:191], v[40:43]
    buffer_load_dwordx4 v24, s[16:19], s34 offen lds
    v_mfma_f32_16x16x32_bf16 v[48:51], v[164:167], v[188:191], v[48:51]
    s_waitcnt vmcnt(6)
    s_barrier
    ds_read_b64_tr_b16 v[148:149], v12 offset:49152
    v_mfma_f32_16x16x32_bf16 v[56:59], v[168:171], v[188:191], v[56:59]
    ds_read_b64_tr_b16 v[150:151], v12 offset:49664
    v_mfma_f32_16x16x32_bf16 v[64:67], v[172:175], v[188:191], v[64:67]
    ds_read_b64_tr_b16 v[152:153], v12 offset:57344
    v_mfma_f32_16x16x32_bf16 v[72:75], v[176:179], v[188:191], v[72:75]
    ds_read_b64_tr_b16 v[154:155], v12 offset:57856
    v_mfma_f32_16x16x32_bf16 v[80:83], v[180:183], v[188:191], v[80:83]
    ds_read_b128 v[116:119], v8 offset:49152
    v_mfma_f32_16x16x32_bf16 v[88:91], v[184:187], v[188:191], v[88:91]
    ds_read_b128 v[120:123], v8 offset:51200
    v_mfma_f32_16x16x32_bf16 v[92:95], v[184:187], v[192:195], v[92:95]
    ds_read_b128 v[124:127], v8 offset:53248
    v_mfma_f32_16x16x32_bf16 v[84:87], v[180:183], v[192:195], v[84:87]
    ds_read_b128 v[128:131], v8 offset:55296
    s_cmp_eq_u32 s28, 0
    s_cbranch_scc0 K_nf1D
    buffer_store_dwordx2 v[6:7], v31, s[20:23], s48 offen sc1
K_nf1D:
    v_mfma_f32_16x16x32_bf16 v[76:79], v[176:179], v[192:195], v[76:79]
    ds_read_b128 v[132:135], v8 offset:57344
    s_lshl_b32 s33, s32, 7
    s_mul_i32 s34, s32, s35
    s_add_u32 s32, s32, 1
    s_cmp_eq_u32 s32, 10
    s_cselect_b32 s32, 0, s32
    s_add_u32 m0, s36, 0
    v_mfma_f32_16x16x32_bf16 v[68:71], v[172:175], v[192:195], v[68:71]
    ds_read_b128 v[136:139], v8 offset:59392
    buffer_load_dwordx4 v20, s[8:11], s33 offen lds
    v_mfma_f32_16x16x32_bf16 v[60:63], v[168:171], v[192:195], v[60:63]
    ds_read_b128 v[140:143], v8 offset:61440
    v_mfma_f32_16x16x32_bf16 v[52:55], v[164:167], v[192:195], v[52:55]
    ds_read_b128 v[144:147], v8 offset:63488
    s_add_u32 m0, s36, 1024
    v_mfma_f32_16x16x32_bf16 v[44:47], v[160:163], v[192:195], v[44:47]
    buffer_load_dwordx4 v21, s[8:11], s33 offen lds
    v_mfma_f32_16x16x32_bf16 v[36:39], v[156:159], v[192:195], v[36:39]
    s_waitcnt lgkmcnt(0)
    v_cndmask_b32 v152, v152, v25, s[70:71]
    v_cndmask_b32 v153, v153, v25, s[70:71]
    v_cndmask_b32 v154, v154, v25, s[70:71]
    v_cndmask_b32 v155, v155, v25, s[70:71]
    v_mfma_f32_16x16x32_bf16 v[32:35], v[116:119], v[148:151], v[32:35]
    ds_read_b64_tr_b16 v[188:189], v14 offset:49152
    v_mfma_f32_16x16x32_bf16 v[40:43], v[120:123], v[148:151], v[40:43]
    ds_read_b64_tr_b16 v[190:191], v14 offset:49664
    v_mfma_f32_16x16x32_bf16 v[48:51], v[124:127], v[148:151], v[48:51]
    ds_read_b64_tr_b16 v[192:193], v14 offset:57344
    s_add_u32 m0, s3, 2048
    v_mfma_f32_16x16x32_bf16 v[56:59], v[128:131], v[148:151], v[56:59]
    ds_read_b64_tr_b16 v[194:195], v14 offset:57856
    buffer_load_dwordx4 v22, s[8:11], s33 offen lds
    v_mfma_f32_16x16x32_bf16 v[64:67], v[132:135], v[148:151], v[64:67]
    ds_read_b128 v[156:159], v9 offset:49152
    v_mfma_f32_16x16x32_bf16 v[72:75], v[136:139], v[148:151], v[72:75]
    ds_read_b128 v[160:163], v9 offset:51200
    v_mfma_f32_16x16x32_bf16 v[80:83], v[140:143], v[148:151], v[80:83]
    ds_read_b128 v[164:167], v9 offset:53248
    v_mfma_f32_16x16x32_bf16 v[88:91], v[144:147], v[148:151], v[88:91]
    ds_read_b128 v[168:171], v9 offset:55296
    s_add_u32 m0, s3, 3072
    v_mfma_f32_16x16x32_bf16 v[92:95], v[144:147], v[152:155], v[92:95]
    ds_read_b128 v[172:175], v9 offset:57344
    buffer_load_dwordx4 v23, s[8:11], s33 offen lds
    v_mfma_f32_16x16x32_bf16 v[84:87], v[140:143], v[152:155], v[84:87]
    ds_read_b128 v[176:179], v9 offset:59392
    v_mfma_f32_16x16x32_bf16 v[76:79], v[136:139], v[152:155], v[76:79]
    ds_read_b128 v[180:183], v9 offset:61440
    v_mfma_f32_16x16x32_bf16 v[68:71], v[132:135], v[152:155], v[68:71]
    ds_read_b128 v[184:187], v9 offset:63488
    v_mfma_f32_16x16x32_bf16 v[60:63], v[128:131], v[152:155], v[60:63]
    s_add_u32 m0, s37, 0
    v_mfma_f32_16x16x32_bf16 v[52:55], v[124:127], v[152:155], v[52:55]
    buffer_load_dwordx4 v24, s[12:15], s34 offen lds
    v_mfma_f32_16x16x32_bf16 v[44:47], v[120:123], v[152:155], v[44:47]
    v_mfma_f32_16x16x32_bf16 v[36:39], v[116:119], v[152:155], v[36:39]
    s_waitcnt lgkmcnt(0)
    v_cndmask_b32 v192, v192, v25, s[70:71]
    v_cndmask_b32 v193, v193, v25, s[70:71]
    v_cndmask_b32 v194, v194, v25, s[70:71]
    v_cndmask_b32 v195, v195, v25, s[70:71]
    v_mfma_f32_16x16x32_bf16 v[32:35], v[156:159], v[188:191], v[32:35]
    s_add_u32 m0, s37, 8192
    v_mfma_f32_16x16x32_bf16 v[40:43], v[160:163], v[188:191], v[40:43]
    buffer_load_dwordx4 v24, s[16:19], s34 offen lds
    v_mfma_f32_16x16x32_bf16 v[48:51], v[164:167], v[188:191], v[48:51]
    s_waitcnt vmcnt(6)
    s_barrier
    ds_read_b64_tr_b16 v[148:149], v16 offset:0
    v_mfma_f32_16x16x32_bf16 v[56:59], v[168:171], v[188:191], v[56:59]
    ds_read_b64_tr_b16 v[150:151], v16 offset:512
    v_mfma_f32_16x16x32_bf16 v[64:67], v[172:175], v[188:191], v[64:67]
    ds_read_b64_tr_b16 v[152:153], v16 offset:8192
    v_mfma_f32_16x16x32_bf16 v[72:75], v[176:179], v[188:191], v[72:75]
    ds_read_b64_tr_b16 v[154:155], v16 offset:8704
    v_mfma_f32_16x16x32_bf16 v[80:83], v[180:183], v[188:191], v[80:83]
    ds_read_b128 v[116:119], v10 offset:0
    v_mfma_f32_16x16x32_bf16 v[88:91], v[184:187], v[188:191], v[88:91]
    ds_read_b128 v[120:123], v10 offset:2048
    v_mfma_f32_16x16x32_bf16 v[92:95], v[184:187], v[192:195], v[92:95]
    ds_read_b128 v[124:127], v10 offset:4096
    v_mfma_f32_16x16x32_bf16 v[84:87], v[180:183], v[192:195], v[84:87]
    ds_read_b128 v[128:131], v10 offset:6144
    v_mfma_f32_16x16x32_bf16 v[76:79], v[176:179], v[192:195], v[76:79]
    ds_read_b128 v[132:135], v10 offset:8192
    s_lshl_b32 s33, s32, 7
    s_mul_i32 s34, s32, s35
    s_add_u32 s32, s32, 1
    s_cmp_eq_u32 s32, 10
    s_cselect_b32 s32, 0, s32
    s_add_u32 m0, s36, 49152
    v_mfma_f32_16x16x32_bf16 v[68:71], v[172:175], v[192:195], v[68:71]
    ds_read_b128 v[136:139], v10 offset:10240
    buffer_load_dwordx4 v20, s[8:11], s33 offen lds
    v_mfma_f32_16x16x32_bf16 v[60:63], v[168:171], v[192:195], v[60:63]
    ds_read_b128 v[140:143], v10 offset:12288
    v_mfma_f32_16x16x32_bf16 v[52:55], v[164:167], v[192:195], v[52:55]
    ds_read_b128 v[144:147], v10 offset:14336
    s_add_u32 m0, s36, 50176
    v_mfma_f32_16x16x32_bf16 v[44:47], v[160:163], v[192:195], v[44:47]
    buffer_load_dwordx4 v21, s[8:11], s33 offen lds
    v_mfma_f32_16x16x32_bf16 v[36:39], v[156:159], v[192:195], v[36:39]
    s_waitcnt lgkmcnt(0)
    v_cndmask_b32 v152, v152, v25, s[70:71]
    v_cndmask_b32 v153, v153, v25, s[70:71]
    v_cndmask_b32 v154, v154, v25, s[70:71]
    v_cndmask_b32 v155, v155, v25, s[70:71]
    v_mfma_f32_16x16x32_bf16 v[32:35], v[116:119], v[148:151], v[32:35]
    ds_read_b64_tr_b16 v[188:189], v18 offset:0
    v_mfma_f32_16x16x32_bf16 v[40:43], v[120:123], v[148:151], v[40:43]
    ds_read_b64_tr_b16 v[190:191], v18 offset:512
    v_mfma_f32_16x16x32_bf16 v[48:51], v[124:127], v[148:151], v[48:51]
    ds_read_b64_tr_b16 v[192:193], v18 offset:8192
    s_add_u32 m0, s3, 51200
    v_mfma_f32_16x16x32_bf16 v[56:59], v[128:131], v[148:151], v[56:59]
    ds_read_b64_tr_b16 v[194:195], v18 offset:8704
    buffer_load_dwordx4 v22, s[8:11], s33 offen lds
    v_mfma_f32_16x16x32_bf16 v[64:67], v[132:135], v[148:151], v[64:67]
    ds_read_b128 v[156:159], v11 offset:0
    v_mfma_f32_16x16x32_bf16 v[72:75], v[136:139], v[148:151], v[72:75]
    ds_read_b128 v[160:163], v11 offset:2048
    v_mfma_f32_16x16x32_bf16 v[80:83], v[140:143], v[148:151], v[80:83]
    ds_read_b128 v[164:167], v11 offset:4096
    v_mfma_f32_16x16x32_bf16 v[88:91], v[144:147], v[148:151], v[88:91]
    ds_read_b128 v[168:171], v11 offset:6144
    s_add_u32 m0, s3, 52224
    v_mfma_f32_16x16x32_bf16 v[92:95], v[144:147], v[152:155], v[92:95]
    ds_read_b128 v[172:175], v11 offset:8192
    buffer_load_dwordx4 v23, s[8:11], s33 offen lds
    v_mfma_f32_16x16x32_bf16 v[84:87], v[140:143], v[152:155], v[84:87]
    ds_read_b128 v[176:179], v11 offset:10240
    v_mfma_f32_16x16x32_bf16 v[76:79], v[136:139], v[152:155], v[76:79]
    ds_read_b128 v[180:183], v11 offset:12288
    v_mfma_f32_16x16x32_bf16 v[68:71], v[132:135], v[152:155], v[68:71]
    ds_read_b128 v[184:187], v11 offset:14336
    v_mfma_f32_16x16x32_bf16 v[60:63], v[128:131], v[152:155], v[60:63]
    s_add_u32 m0, s37, 49152
    v_mfma_f32_16x16x32_bf16 v[52:55], v[124:127], v[152:155], v[52:55]
    buffer_load_dwordx4 v24, s[12:15], s34 offen lds
    v_mfma_f32_16x16x32_bf16 v[44:47], v[120:123], v[152:155], v[44:47]
    v_mfma_f32_16x16x32_bf16 v[36:39], v[116:119], v[152:155], v[36:39]
    s_waitcnt lgkmcnt(0)
    v_cndmask_b32 v192, v192, v25, s[70:71]
    v_cndmask_b32 v193, v193, v25, s[70:71]
    v_cndmask_b32 v194, v194, v25, s[70:71]
    v_cndmask_b32 v195, v195, v25, s[70:71]
    v_mfma_f32_16x16x32_bf16 v[32:35], v[156:159], v[188:191], v[32:35]
    s_add_u32 m0, s37, 57344
    v_mfma_f32_16x16x32_bf16 v[40:43], v[160:163], v[188:191], v[40:43]
    buffer_load_dwordx4 v24, s[16:19], s34 offen lds
    v_mfma_f32_16x16x32_bf16 v[48:51], v[164:167], v[188:191], v[48:51]
    s_waitcnt vmcnt(6)
    s_barrier
    ds_read_b64_tr_b16 v[148:149], v12 offset:0
    v_mfma_f32_16x16x32_bf16 v[56:59], v[168:171], v[188:191], v[56:59]
    ds_read_b64_tr_b16 v[150:151], v12 offset:512
    v_mfma_f32_16x16x32_bf16 v[64:67], v[172:175], v[188:191], v[64:67]
    ds_read_b64_tr_b16 v[152:153], v12 offset:8192
    v_mfma_f32_16x16x32_bf16 v[72:75], v[176:179], v[188:191], v[72:75]
    ds_read_b64_tr_b16 v[154:155], v12 offset:8704
    v_mfma_f32_16x16x32_bf16 v[80:83], v[180:183], v[188:191], v[80:83]
    ds_read_b128 v[116:119], v8 offset:0
    v_mfma_f32_16x16x32_bf16 v[88:91], v[184:187], v[188:191], v[88:91]
    ds_read_b128 v[120:123], v8 offset:2048
    v_mfma_f32_16x16x32_bf16 v[92:95], v[184:187], v[192:195], v[92:95]
    ds_read_b128 v[124:127], v8 offset:4096
    v_mfma_f32_16x16x32_bf16 v[84:87], v[180:183], v[192:195], v[84:87]
    ds_read_b128 v[128:131], v8 offset:6144
    v_mfma_f32_16x16x32_bf16 v[76:79], v[176:179], v[192:195], v[76:79]
    ds_read_b128 v[132:135], v8 offset:8192
    s_lshl_b32 s33, s32, 7
    s_mul_i32 s34, s32, s35
    s_add_u32 s32, s32, 1
    s_cmp_eq_u32 s32, 10
    s_cselect_b32 s32, 0, s32
    s_add_u32 m0, s36, 98304
    v_mfma_f32_16x16x32_bf16 v[68:71], v[172:175], v[192:195], v[68:71]
    ds_read_b128 v[136:139], v8 offset:10240
    buffer_load_dwordx4 v20, s[8:11], s33 offen lds
    v_mfma_f32_16x16x32_bf16 v[60:63], v[168:171], v[192:195], v[60:63]
    ds_read_b128 v[140:143], v8 offset:12288
    v_mfma_f32_16x16x32_bf16 v[52:55], v[164:167], v[192:195], v[52:55]
    ds_read_b128 v[144:147], v8 offset:14336
    s_add_u32 m0, s36, 99328
    v_mfma_f32_16x16x32_bf16 v[44:47], v[160:163], v[192:195], v[44:47]
    buffer_load_dwordx4 v21, s[8:11], s33 offen lds
    v_mfma_f32_16x16x32_bf16 v[36:39], v[156:159], v[192:195], v[36:39]
    s_waitcnt lgkmcnt(0)
    v_cndmask_b32 v152, v152, v25, s[70:71]
    v_cndmask_b32 v153, v153, v25, s[70:71]
    v_cndmask_b32 v154, v154, v25, s[70:71]
    v_cndmask_b32 v155, v155, v25, s[70:71]
    v_mfma_f32_16x16x32_bf16 v[32:35], v[116:119], v[148:151], v[32:35]
    ds_read_b64_tr_b16 v[188:189], v14 offset:0
    v_mfma_f32_16x16x32_bf16 v[40:43], v[120:123], v[148:151], v[40:43]
    ds_read_b64_tr_b16 v[190:191], v14 offset:512
    v_mfma_f32_16x16x32_bf16 v[48:51], v[124:127], v[148:151], v[48:51]
    ds_read_b64_tr_b16 v[192:193], v14 offset:8192
    s_add_u32 m0, s3, 100352
    v_mfma_f32_16x16x32_bf16 v[56:59], v[128:131], v[148:151], v[56:59]
    ds_read_b64_tr_b16 v[194:195], v14 offset:8704
    buffer_load_dwordx4 v22, s[8:11], s33 offen lds
    v_mfma_f32_16x16x32_bf16 v[64:67], v[132:135], v[148:151], v[64:67]
    ds_read_b128 v[156:159], v9 offset:0
    v_mfma_f32_16x16x32_bf16 v[72:75], v[136:139], v[148:151], v[72:75]
    ds_read_b128 v[160:163], v9 offset:2048
    s_mov_b32 s61, 15794176
    v_lshlrev_b32 v30, 5, v1
    s_cmp_eq_u32 s28, 7
    s_cbranch_scc0 K_np1D
    buffer_load_dwordx4 v[240:243], v30, s[20:23], s61 offen sc1
    buffer_load_dwordx4 v[244:247], v30, s[20:23], s61 offen offset:16 sc1
K_np1D:
    v_mfma_f32_16x16x32_bf16 v[80:83], v[140:143], v[148:151], v[80:83]
    ds_read_b128 v[164:167], v9 offset:4096
    v_mfma_f32_16x16x32_bf16 v[88:91], v[144:147], v[148:151], v[88:91]
    ds_read_b128 v[168:171], v9 offset:6144
    s_add_u32 m0, s3, 101376
    v_mfma_f32_16x16x32_bf16 v[92:95], v[144:147], v[152:155], v[92:95]
    ds_read_b128 v[172:175], v9 offset:8192
    buffer_load_dwordx4 v23, s[8:11], s33 offen lds
    v_mfma_f32_16x16x32_bf16 v[84:87], v[140:143], v[152:155], v[84:87]
    ds_read_b128 v[176:179], v9 offset:10240
    v_mfma_f32_16x16x32_bf16 v[76:79], v[136:139], v[152:155], v[76:79]
    ds_read_b128 v[180:183], v9 offset:12288
    v_mfma_f32_16x16x32_bf16 v[68:71], v[132:135], v[152:155], v[68:71]
    ds_read_b128 v[184:187], v9 offset:14336
    v_mfma_f32_16x16x32_bf16 v[60:63], v[128:131], v[152:155], v[60:63]
    s_add_u32 m0, s37, 98304
    v_mfma_f32_16x16x32_bf16 v[52:55], v[124:127], v[152:155], v[52:55]
    buffer_load_dwordx4 v24, s[12:15], s34 offen lds
    v_mfma_f32_16x16x32_bf16 v[44:47], v[120:123], v[152:155], v[44:47]
    v_mfma_f32_16x16x32_bf16 v[36:39], v[116:119], v[152:155], v[36:39]
    s_waitcnt lgkmcnt(0)
    v_cndmask_b32 v192, v192, v25, s[70:71]
    v_cndmask_b32 v193, v193, v25, s[70:71]
    v_cndmask_b32 v194, v194, v25, s[70:71]
    v_cndmask_b32 v195, v195, v25, s[70:71]
    v_mfma_f32_16x16x32_bf16 v[32:35], v[156:159], v[188:191], v[32:35]
    s_add_u32 m0, s37, 106496
    v_mfma_f32_16x16x32_bf16 v[40:43], v[160:163], v[188:191], v[40:43]
    buffer_load_dwordx4 v24, s[16:19], s34 offen lds
    v_mfma_f32_16x16x32_bf16 v[48:51], v[164:167], v[188:191], v[48:51]
    s_waitcnt vmcnt(6)
    s_barrier
    ds_read_b64_tr_b16 v[148:149], v12 offset:49152
    v_mfma_f32_16x16x32_bf16 v[56:59], v[168:171], v[188:191], v[56:59]
    ds_read_b64_tr_b16 v[150:151], v12 offset:49664
    v_mfma_f32_16x16x32_bf16 v[64:67], v[172:175], v[188:191], v[64:67]
    ds_read_b64_tr_b16 v[152:153], v12 offset:57344
    v_mfma_f32_16x16x32_bf16 v[72:75], v[176:179], v[188:191], v[72:75]
    ds_read_b64_tr_b16 v[154:155], v12 offset:57856
    v_mfma_f32_16x16x32_bf16 v[80:83], v[180:183], v[188:191], v[80:83]
    ds_read_b128 v[116:119], v8 offset:49152
    v_mfma_f32_16x16x32_bf16 v[88:91], v[184:187], v[188:191], v[88:91]
    ds_read_b128 v[120:123], v8 offset:51200
    v_mfma_f32_16x16x32_bf16 v[92:95], v[184:187], v[192:195], v[92:95]
    ds_read_b128 v[124:127], v8 offset:53248
    v_mfma_f32_16x16x32_bf16 v[84:87], v[180:183], v[192:195], v[84:87]
    ds_read_b128 v[128:131], v8 offset:55296
    v_mfma_f32_16x16x32_bf16 v[76:79], v[176:179], v[192:195], v[76:79]
    ds_read_b128 v[132:135], v8 offset:57344
    s_lshl_b32 s33, s32, 7
    s_mul_i32 s34, s32, s35
    s_add_u32 s32, s32, 1
    s_cmp_eq_u32 s32, 10
    s_cselect_b32 s32, 0, s32
    s_add_u32 m0, s36, 0
    v_mfma_f32_16x16x32_bf16 v[68:71], v[172:175], v[192:195], v[68:71]
    ds_read_b128 v[136:139], v8 offset:59392
    buffer_load_dwordx4 v20, s[8:11], s33 offen lds
    v_mfma_f32_16x16x32_bf16 v[60:63], v[168:171], v[192:195], v[60:63]
    ds_read_b128 v[140:143], v8 offset:61440
    v_mfma_f32_16x16x32_bf16 v[52:55], v[164:167], v[192:195], v[52:55]
    ds_read_b128 v[144:147], v8 offset:63488
    s_add_u32 m0, s36, 1024
    v_mfma_f32_16x16x32_bf16 v[44:47], v[160:163], v[192:195], v[44:47]
    buffer_load_dwordx4 v21, s[8:11], s33 offen lds
    v_mfma_f32_16x16x32_bf16 v[36:39], v[156:159], v[192:195], v[36:39]
    s_waitcnt lgkmcnt(0)
    v_cndmask_b32 v152, v152, v25, s[70:71]
    v_cndmask_b32 v153, v153, v25, s[70:71]
    v_cndmask_b32 v154, v154, v25, s[70:71]
    v_cndmask_b32 v155, v155, v25, s[70:71]
    v_mfma_f32_16x16x32_bf16 v[32:35], v[116:119], v[148:151], v[32:35]
    ds_read_b64_tr_b16 v[188:189], v14 offset:49152
    v_mfma_f32_16x16x32_bf16 v[40:43], v[120:123], v[148:151], v[40:43]
    ds_read_b64_tr_b16 v[190:191], v14 offset:49664
    v_mfma_f32_16x16x32_bf16 v[48:51], v[124:127], v[148:151], v[48:51]
    ds_read_b64_tr_b16 v[192:193], v14 offset:57344
    s_add_u32 m0, s3, 2048
    v_mfma_f32_16x16x32_bf16 v[56:59], v[128:131], v[148:151], v[56:59]
    ds_read_b64_tr_b16 v[194:195], v14 offset:57856
    buffer_load_dwordx4 v22, s[8:11], s33 offen lds
    v_mfma_f32_16x16x32_bf16 v[64:67], v[132:135], v[148:151], v[64:67]
    ds_read_b128 v[156:159], v9 offset:49152
    v_mfma_f32_16x16x32_bf16 v[72:75], v[136:139], v[148:151], v[72:75]
    ds_read_b128 v[160:163], v9 offset:51200
    v_mfma_f32_16x16x32_bf16 v[80:83], v[140:143], v[148:151], v[80:83]
    ds_read_b128 v[164:167], v9 offset:53248
    v_mfma_f32_16x16x32_bf16 v[88:91], v[144:147], v[148:151], v[88:91]
    ds_read_b128 v[168:171], v9 offset:55296
    s_add_u32 m0, s3, 3072
    v_mfma_f32_16x16x32_bf16 v[92:95], v[144:147], v[152:155], v[92:95]
    ds_read_b128 v[172:175], v9 offset:57344
    buffer_load_dwordx4 v23, s[8:11], s33 offen lds
    v_mfma_f32_16x16x32_bf16 v[84:87], v[140:143], v[152:155], v[84:87]
    ds_read_b128 v[176:179], v9 offset:59392
    v_mfma_f32_16x16x32_bf16 v[76:79], v[136:139], v[152:155], v[76:79]
    ds_read_b128 v[180:183], v9 offset:61440
    v_mfma_f32_16x16x32_bf16 v[68:71], v[132:135], v[152:155], v[68:71]
    ds_read_b128 v[184:187], v9 offset:63488
    v_mfma_f32_16x16x32_bf16 v[60:63], v[128:131], v[152:155], v[60:63]
    s_add_u32 m0, s37, 0
    v_mfma_f32_16x16x32_bf16 v[52:55], v[124:127], v[152:155], v[52:55]
    buffer_load_dwordx4 v24, s[12:15], s34 offen lds
    v_mfma_f32_16x16x32_bf16 v[44:47], v[120:123], v[152:155], v[44:47]
    v_mfma_f32_16x16x32_bf16 v[36:39], v[116:119], v[152:155], v[36:39]
    s_waitcnt lgkmcnt(0)
    v_cndmask_b32 v192, v192, v25, s[70:71]
    v_cndmask_b32 v193, v193, v25, s[70:71]
    v_cndmask_b32 v194, v194, v25, s[70:71]
    v_cndmask_b32 v195, v195, v25, s[70:71]
    v_mfma_f32_16x16x32_bf16 v[32:35], v[156:159], v[188:191], v[32:35]
    s_add_u32 m0, s37, 8192
    v_mfma_f32_16x16x32_bf16 v[40:43], v[160:163], v[188:191], v[40:43]
    buffer_load_dwordx4 v24, s[16:19], s34 offen lds
    v_mfma_f32_16x16x32_bf16 v[48:51], v[164:167], v[188:191], v[48:51]
    s_waitcnt vmcnt(6)
    s_cmp_eq_u32 s28, 7
    s_cbranch_scc0 K_back1D
    v_cmp_ne_u64 vcc, s[72:73], v[240:241]
    v_cmp_ne_u64 s[80:81], s[72:73], v[242:243]
    v_cmp_ne_u64 s[82:83], s[72:73], v[244:245]
    v_cmp_ne_u64 s[44:45], s[72:73], v[246:247]
    s_nop 0
    s_or_b64 s[80:81], s[80:81], s[82:83]
    s_or_b64 vcc, vcc, s[44:45]
    s_or_b64 vcc, vcc, s[80:81]
    s_cbranch_vccnz K_slow1D
K_back1D:
    s_barrier
    ds_read_b64_tr_b16 v[148:149], v16 offset:0
    v_mfma_f32_16x16x32_bf16 v[56:59], v[168:171], v[188:191], v[56:59]
    ds_read_b64_tr_b16 v[150:151], v16 offset:512
    v_mfma_f32_16x16x32_bf16 v[64:67], v[172:175], v[188:191], v[64:67]
    ds_read_b64_tr_b16 v[152:153], v16 offset:8192
    v_mfma_f32_16x16x32_bf16 v[72:75], v[176:179], v[188:191], v[72:75]
    ds_read_b64_tr_b16 v[154:155], v16 offset:8704
    v_mfma_f32_16x16x32_bf16 v[80:83], v[180:183], v[188:191], v[80:83]
    ds_read_b128 v[116:119], v10 offset:0
    v_mfma_f32_16x16x32_bf16 v[88:91], v[184:187], v[188:191], v[88:91]
    ds_read_b128 v[120:123], v10 offset:2048
    v_mfma_f32_16x16x32_bf16 v[92:95], v[184:187], v[192:195], v[92:95]
    ds_read_b128 v[124:127], v10 offset:4096
    v_mfma_f32_16x16x32_bf16 v[84:87], v[180:183], v[192:195], v[84:87]
    ds_read_b128 v[128:131], v10 offset:6144
    s_lshl_b32 s61, s29, 12
    s_add_u32 s61, s61, 15761408
    s_lshl_b32 s54, s28, 5
    v_and_b32 v27, 31, v1
    v_add_u32 v27, s54, v27
    v_lshrrev_b32 v26, 5, v1
    v_lshlrev_b32 v30, 2, v26
    v_lshl_add_u32 v30, v27, 4, v30
    v_lshlrev_b32 v27, 2, v27
    v_lshl_add_u32 v27, v26, 10, v27
    v_mov_b32 v28, 1142947840
    v_cndmask_b32 v28, 0, v28, s[70:71]
    buffer_load_dword v29, v30, s[20:23], s61 offen sc1
    v_mfma_f32_16x16x32_bf16 v[76:79], v[176:179], v[192:195], v[76:79]
    ds_read_b128 v[132:135], v10 offset:8192
    v_mfma_f32_16x16x32_bf16 v[68:71], v[172:175], v[192:195], v[68:71]
    ds_read_b128 v[136:139], v10 offset:10240
    v_mfma_f32_16x16x32_bf16 v[60:63], v[168:171], v[192:195], v[60:63]
    ds_read_b128 v[140:143], v10 offset:12288
    v_mfma_f32_16x16x32_bf16 v[52:55], v[164:167], v[192:195], v[52:55]
    ds_read_b128 v[144:147], v10 offset:14336
    s_add_u32 s39, s43, 0
    buffer_load_dwordx4 v[196:199], v2, s[20:23], s39 offen offset:0 sc1
    v_mfma_f32_16x16x32_bf16 v[44:47], v[160:163], v[192:195], v[44:47]
    v_mfma_f32_16x16x32_bf16 v[36:39], v[156:159], v[192:195], v[36:39]
    s_waitcnt lgkmcnt(0)
    v_cndmask_b32 v152, v152, v25, s[70:71]
    v_cndmask_b32 v153, v153, v25, s[70:71]
    v_cndmask_b32 v154, v154, v25, s[70:71]
    v_cndmask_b32 v155, v155, v25, s[70:71]
    v_mfma_f32_16x16x32_bf16 v[32:35], v[116:119], v[148:151], v[32:35]
    ds_read_b64_tr_b16 v[188:189], v18 offset:0
    v_mfma_f32_16x16x32_bf16 v[40:43], v[120:123], v[148:151], v[40:43]
    ds_read_b64_tr_b16 v[190:191], v18 offset:512
    buffer_load_dwordx4 v[200:203], v2, s[20:23], s39 offen offset:1024 sc1
    v_mfma_f32_16x16x32_bf16 v[48:51], v[124:127], v[148:151], v[48:51]
    ds_read_b64_tr_b16 v[192:193], v18 offset:8192
    v_mfma_f32_16x16x32_bf16 v[56:59], v[128:131], v[148:151], v[56:59]
    ds_read_b64_tr_b16 v[194:195], v18 offset:8704
    v_mfma_f32_16x16x32_bf16 v[64:67], v[132:135], v[148:151], v[64:67]
    ds_read_b128 v[156:159], v11 offset:0
    v_mfma_f32_16x16x32_bf16 v[72:75], v[136:139], v[148:151], v[72:75]
    ds_read_b128 v[160:163], v11 offset:2048
    v_mfma_f32_16x16x32_bf16 v[80:83], v[140:143], v[148:151], v[80:83]
    ds_read_b128 v[164:167], v11 offset:4096
    buffer_load_dwordx4 v[204:207], v2, s[20:23], s39 offen offset:2048 sc1
    v_mfma_f32_16x16x32_bf16 v[88:91], v[144:147], v[148:151], v[88:91]
    ds_read_b128 v[168:171], v11 offset:6144
    v_mfma_f32_16x16x32_bf16 v[92:95], v[144:147], v[152:155], v[92:95]
    ds_read_b128 v[172:175], v11 offset:8192
    v_mfma_f32_16x16x32_bf16 v[84:87], v[140:143], v[152:155], v[84:87]
    ds_read_b128 v[176:179], v11 offset:10240
    v_mfma_f32_16x16x32_bf16 v[76:79], v[136:139], v[152:155], v[76:79]
    ds_read_b128 v[180:183], v11 offset:12288
    buffer_load_dwordx4 v[208:211], v2, s[20:23], s39 offen offset:3072 sc1
    v_mfma_f32_16x16x32_bf16 v[68:71], v[132:135], v[152:155], v[68:71]
    ds_read_b128 v[184:187], v11 offset:14336
    v_mfma_f32_16x16x32_bf16 v[60:63], v[128:131], v[152:155], v[60:63]
    v_mfma_f32_16x16x32_bf16 v[52:55], v[124:127], v[152:155], v[52:55]
    v_mfma_f32_16x16x32_bf16 v[44:47], v[120:123], v[152:155], v[44:47]
    buffer_load_dwordx4 v[212:215], v3, s[20:23], s39 offen sc1
    v_mfma_f32_16x16x32_bf16 v[36:39], v[116:119], v[152:155], v[36:39]
    s_waitcnt lgkmcnt(0)
    v_cndmask_b32 v192, v192, v25, s[70:71]
    v_cndmask_b32 v193, v193, v25, s[70:71]
    v_cndmask_b32 v194, v194, v25, s[70:71]
    v_cndmask_b32 v195, v195, v25, s[70:71]
    v_mfma_f32_16x16x32_bf16 v[32:35], v[156:159], v[188:191], v[32:35]
    s_waitcnt vmcnt(5)
    v_add_u32 v27, 155648, v27
    ds_write_b32 v27, v29
    s_and_b32 s54, s28, 4
    s_lshl_b32 s54, s54, 7
    s_add_u32 s54, s54, 155648
    v_lshrrev_b32 v27, 4, v1
    v_lshl_add_u32 v27, v27, 4, s54
    v_mfma_f32_16x16x32_bf16 v[40:43], v[160:163], v[188:191], v[40:43]
    v_mfma_f32_16x16x32_bf16 v[48:51], v[164:167], v[188:191], v[48:51]
    s_waitcnt vmcnt(6) lgkmcnt(0)
    s_barrier
    s_cmp_ge_u32 s28, 4
    s_cbranch_scc0 K_tpD
    s_setprio 1
K_tpD:
    ds_read_b64_tr_b16 v[148:149], v12 offset:0
    v_mfma_f32_16x16x32_bf16 v[56:59], v[168:171], v[188:191], v[56:59]
    ds_read_b64_tr_b16 v[150:151], v12 offset:512
    s_add_u32 s39, s43, 5120
    buffer_load_dwordx4 v[216:219], v2, s[20:23], s39 offen offset:0 sc1
    v_mfma_f32_16x16x32_bf16 v[64:67], v[172:175], v[188:191], v[64:67]
    ds_read_b64_tr_b16 v[152:153], v12 offset:8192
    v_mfma_f32_16x16x32_bf16 v[72:75], v[176:179], v[188:191], v[72:75]
    ds_read_b64_tr_b16 v[154:155], v12 offset:8704
    v_mfma_f32_16x16x32_bf16 v[80:83], v[180:183], v[188:191], v[80:83]
    ds_read_b128 v[116:119], v8 offset:0
    v_mfma_f32_16x16x32_bf16 v[88:91], v[184:187], v[188:191], v[88:91]
    ds_read_b128 v[120:123], v8 offset:2048
    buffer_load_dwordx4 v[220:223], v2, s[20:23], s39 offen offset:1024 sc1
    v_mfma_f32_16x16x32_bf16 v[92:95], v[184:187], v[192:195], v[92:95]
    ds_read_b128 v[124:127], v8 offset:4096
    v_mfma_f32_16x16x32_bf16 v[84:87], v[180:183], v[192:195], v[84:87]
    ds_read_b128 v[128:131], v8 offset:6144
    s_lshl_b32 s54, s28, 11
    s_add_u32 s54, s54, 86016
    v_add_u32 v30, s54, v2
    ds_write_b128 v30, v[104:107]
    ds_write_b128 v30, v[108:111] offset:1024
    v_lshlrev_b32 v30, 2, v1
    v_add_u32 v30, 143360, v30
    ds_write_b32 v30, v4
    v_mfma_f32_16x16x32_bf16 v[76:79], v[176:179], v[192:195], v[76:79]
    ds_read_b128 v[132:135], v8 offset:8192
    v_mfma_f32_16x16x32_bf16 v[68:71], v[172:175], v[192:195], v[68:71]
    ds_read_b128 v[136:139], v8 offset:10240
    v_mfma_f32_16x16x32_bf16 v[60:63], v[168:171], v[192:195], v[60:63]
    ds_read_b128 v[140:143], v8 offset:12288
    buffer_load_dwordx4 v[224:227], v2, s[20:23], s39 offen offset:2048 sc1
    v_mfma_f32_16x16x32_bf16 v[52:55], v[164:167], v[192:195], v[52:55]
    ds_read_b128 v[144:147], v8 offset:14336
    v_mfma_f32_16x16x32_bf16 v[44:47], v[160:163], v[192:195], v[44:47]
    v_mfma_f32_16x16x32_bf16 v[36:39], v[156:159], v[192:195], v[36:39]
    s_waitcnt lgkmcnt(0)
    v_cndmask_b32 v152, v152, v25, s[70:71]
    v_cndmask_b32 v153, v153, v25, s[70:71]
    v_cndmask_b32 v154, v154, v25, s[70:71]
    v_cndmask_b32 v155, v155, v25, s[70:71]
    v_mfma_f32_16x16x32_bf16 v[32:35], v[116:119], v[148:151], v[32:35]
    ds_read_b64_tr_b16 v[188:189], v14 offset:0
    buffer_load_dwordx4 v[228:231], v2, s[20:23], s39 offen offset:3072 sc1
    v_mfma_f32_16x16x32_bf16 v[40:43], v[120:123], v[148:151], v[40:43]
    ds_read_b64_tr_b16 v[190:191], v14 offset:512
    v_mfma_f32_16x16x32_bf16 v[48:51], v[124:127], v[148:151], v[48:51]
    ds_read_b64_tr_b16 v[192:193], v14 offset:8192
    v_mfma_f32_16x16x32_bf16 v[56:59], v[128:131], v[148:151], v[56:59]
    ds_read_b64_tr_b16 v[194:195], v14 offset:8704
    v_mfma_f32_16x16x32_bf16 v[64:67], v[132:135], v[148:151], v[64:67]
    ds_read_b128 v[156:159], v9 offset:0
    buffer_load_dwordx4 v[232:235], v3, s[20:23], s39 offen sc1
    v_mfma_f32_16x16x32_bf16 v[72:75], v[136:139], v[148:151], v[72:75]
    ds_read_b128 v[160:163], v9 offset:2048
    v_mfma_f32_16x16x32_bf16 v[80:83], v[140:143], v[148:151], v[80:83]
    ds_read_b128 v[164:167], v9 offset:4096
    v_mfma_f32_16x16x32_bf16 v[88:91], v[144:147], v[148:151], v[88:91]
    ds_read_b128 v[168:171], v9 offset:6144
    v_mfma_f32_16x16x32_bf16 v[92:95], v[144:147], v[152:155], v[92:95]
    ds_read_b128 v[172:175], v9 offset:8192
    v_mfma_f32_16x16x32_bf16 v[84:87], v[140:143], v[152:155], v[84:87]
    ds_read_b128 v[176:179], v9 offset:10240
    s_add_u32 s39, s43, 10240
    buffer_load_dwordx4 v[236:239], v2, s[20:23], s39 offen offset:0 sc1
    v_mfma_f32_16x16x32_bf16 v[76:79], v[136:139], v[152:155], v[76:79]
    ds_read_b128 v[180:183], v9 offset:12288
    v_mfma_f32_16x16x32_bf16 v[68:71], v[132:135], v[152:155], v[68:71]
    ds_read_b128 v[184:187], v9 offset:14336
    v_mfma_f32_16x16x32_bf16 v[60:63], v[128:131], v[152:155], v[60:63]
    v_mfma_f32_16x16x32_bf16 v[52:55], v[124:127], v[152:155], v[52:55]
    buffer_load_dwordx4 v[240:243], v2, s[20:23], s39 offen offset:1024 sc1
    v_mfma_f32_16x16x32_bf16 v[44:47], v[120:123], v[152:155], v[44:47]
    v_mfma_f32_16x16x32_bf16 v[36:39], v[116:119], v[152:155], v[36:39]
    s_waitcnt lgkmcnt(0)
    v_cndmask_b32 v192, v192, v25, s[70:71]
    v_cndmask_b32 v193, v193, v25, s[70:71]
    v_cndmask_b32 v194, v194, v25, s[70:71]
    v_cndmask_b32 v195, v195, v25, s[70:71]
    v_mfma_f32_16x16x32_bf16 v[32:35], v[156:159], v[188:191], v[32:35]
    v_mfma_f32_16x16x32_bf16 v[40:43], v[160:163], v[188:191], v[40:43]
    buffer_load_dwordx4 v[244:247], v2, s[20:23], s39 offen offset:2048 sc1
    v_mfma_f32_16x16x32_bf16 v[48:51], v[164:167], v[188:191], v[48:51]
    v_add_u32 v26, 147456, v2
    ds_read_b128 v[96:99], v26 offset:2048
    ds_read_b128 v[100:103], v26 offset:3072
    ds_read_b128 v[8:11], v27 offset:0
    ds_read_b128 v[12:15], v27 offset:1024
    ds_read_b128 v[16:19], v27 offset:64
    ds_read_b128 v[20:23], v27 offset:1088
    v_mfma_f32_16x16x32_bf16 v[56:59], v[168:171], v[188:191], v[56:59]
    v_mfma_f32_16x16x32_bf16 v[64:67], v[172:175], v[188:191], v[64:67]
    v_mfma_f32_16x16x32_bf16 v[72:75], v[176:179], v[188:191], v[72:75]
    v_mfma_f32_16x16x32_bf16 v[80:83], v[180:183], v[188:191], v[80:83]
    buffer_load_dwordx4 v[248:251], v2, s[20:23], s39 offen offset:3072 sc1
    v_mfma_f32_16x16x32_bf16 v[88:91], v[184:187], v[188:191], v[88:91]
    v_mfma_f32_16x16x32_bf16 v[92:95], v[184:187], v[192:195], v[92:95]
    v_mfma_f32_16x16x32_bf16 v[84:87], v[180:183], v[192:195], v[84:87]
    v_mfma_f32_16x16x32_bf16 v[76:79], v[176:179], v[192:195], v[76:79]
    buffer_load_dwordx4 v[252:255], v3, s[20:23], s39 offen sc1
    v_mfma_f32_16x16x32_bf16 v[68:71], v[172:175], v[192:195], v[68:71]
    v_mfma_f32_16x16x32_bf16 v[60:63], v[168:171], v[192:195], v[60:63]
    v_mfma_f32_16x16x32_bf16 v[52:55], v[164:167], v[192:195], v[52:55]
    v_mfma_f32_16x16x32_bf16 v[44:47], v[160:163], v[192:195], v[44:47]
    v_mfma_f32_16x16x32_bf16 v[36:39], v[156:159], v[192:195], v[36:39]
    s_setprio 0
    s_lshl_b32 s61, s59, 6
    s_and_b32 s62, s28, 3
    s_lshl_b32 s62, s62, 4
    s_add_u32 s61, s61, s62
    v_and_b32 v24, 15, v1
    v_add_u32 v24, s61, v24
    v_lshrrev_b32 v25, 4, v1
    v_mul_u32_u24 v25, 21504, v25
    v_add_u32 v24, v24, v25
    v_lshlrev_b32 v24, 4, v24
    v_lshlrev_b32 v25, 4, v25
    v_add_u32 v25, 5120, v25
    s_lshl_b32 s62, s29, 1
    s_lshr_b32 s54, s28, 2
    s_add_u32 s62, s62, s54
    s_mul_i32 s62, s62, 5376
    s_add_u32 s62, s62, 12582912
    s_waitcnt lgkmcnt(2)
    v_pk_fma_f32 v[32:33], v[8:9], v[28:29], v[32:33] op_sel_hi:[1,0,1] neg_lo:[1,0,0] neg_hi:[1,0,0]
    v_pk_fma_f32 v[34:35], v[10:11], v[28:29], v[34:35] op_sel_hi:[1,0,1] neg_lo:[1,0,0] neg_hi:[1,0,0]
    s_add_u32 s39, s43, 15360
    buffer_load_dwordx4 v[136:139], v2, s[20:23], s39 offen offset:0 sc1
    v_pk_mul_f32 v[36:37], v[12:13], v[36:37]
    v_pk_mul_f32 v[38:39], v[14:15], v[38:39]
    v_pk_mul_f32 v[32:33], v[12:13], v[32:33]
    v_pk_mul_f32 v[34:35], v[14:15], v[34:35]
    ds_read_b128 v[8:11], v27 offset:128
    ds_read_b128 v[12:15], v27 offset:1152
    v_cvt_pk_bf16_f32 v104, v32, v33
    v_cvt_pk_bf16_f32 v105, v34, v35
    v_cvt_pk_bf16_f32 v108, v36, v37
    v_cvt_pk_bf16_f32 v109, v38, v39
    s_waitcnt lgkmcnt(2)
    v_pk_fma_f32 v[40:41], v[16:17], v[28:29], v[40:41] op_sel_hi:[1,0,1] neg_lo:[1,0,0] neg_hi:[1,0,0]
    v_pk_fma_f32 v[42:43], v[18:19], v[28:29], v[42:43] op_sel_hi:[1,0,1] neg_lo:[1,0,0] neg_hi:[1,0,0]
    buffer_load_dwordx4 v[140:143], v2, s[20:23], s39 offen offset:1024 sc1
    v_pk_mul_f32 v[44:45], v[20:21], v[44:45]
    v_pk_mul_f32 v[46:47], v[22:23], v[46:47]
    v_pk_mul_f32 v[40:41], v[20:21], v[40:41]
    v_pk_mul_f32 v[42:43], v[22:23], v[42:43]
    ds_read_b128 v[16:19], v27 offset:192
    ds_read_b128 v[20:23], v27 offset:1216
    v_cvt_pk_bf16_f32 v106, v40, v41
    v_cvt_pk_bf16_f32 v107, v42, v43
    v_cvt_pk_bf16_f32 v110, v44, v45
    v_cvt_pk_bf16_f32 v111, v46, v47
    s_waitcnt lgkmcnt(2)
    v_pk_fma_f32 v[48:49], v[8:9], v[28:29], v[48:49] op_sel_hi:[1,0,1] neg_lo:[1,0,0] neg_hi:[1,0,0]
    v_pk_fma_f32 v[50:51], v[10:11], v[28:29], v[50:51] op_sel_hi:[1,0,1] neg_lo:[1,0,0] neg_hi:[1,0,0]
    buffer_load_dwordx4 v[144:147], v2, s[20:23], s39 offen offset:2048 sc1
    v_pk_mul_f32 v[52:53], v[12:13], v[52:53]
    v_pk_mul_f32 v[54:55], v[14:15], v[54:55]
    v_pk_mul_f32 v[48:49], v[12:13], v[48:49]
    v_pk_mul_f32 v[50:51], v[14:15], v[50:51]
    ds_read_b128 v[8:11], v27 offset:256
    ds_read_b128 v[12:15], v27 offset:1280
    v_cvt_pk_bf16_f32 v112, v48, v49
    v_cvt_pk_bf16_f32 v113, v50, v51
    v_cvt_pk_bf16_f32 v116, v52, v53
    v_cvt_pk_bf16_f32 v117, v54, v55
    s_waitcnt lgkmcnt(2)
    v_pk_fma_f32 v[56:57], v[16:17], v[28:29], v[56:57] op_sel_hi:[1,0,1] neg_lo:[1,0,0] neg_hi:[1,0,0]
    v_pk_fma_f32 v[58:59], v[18:19], v[28:29], v[58:59] op_sel_hi:[1,0,1] neg_lo:[1,0,0] neg_hi:[1,0,0]
    buffer_load_dwordx4 v[148:151], v2, s[20:23], s39 offen offset:3072 sc1
    v_pk_mul_f32 v[60:61], v[20:21], v[60:61]
    v_pk_mul_f32 v[62:63], v[22:23], v[62:63]
    v_pk_mul_f32 v[56:57], v[20:21], v[56:57]
    v_pk_mul_f32 v[58:59], v[22:23], v[58:59]
    ds_read_b128 v[16:19], v27 offset:320
    ds_read_b128 v[20:23], v27 offset:1344
    v_cvt_pk_bf16_f32 v114, v56, v57
    v_cvt_pk_bf16_f32 v115, v58, v59
    v_cvt_pk_bf16_f32 v118, v60, v61
    v_cvt_pk_bf16_f32 v119, v62, v63
    s_waitcnt lgkmcnt(2)
    v_pk_fma_f32 v[64:65], v[8:9], v[28:29], v[64:65] op_sel_hi:[1,0,1] neg_lo:[1,0,0] neg_hi:[1,0,0]
    v_pk_fma_f32 v[66:67], v[10:11], v[28:29], v[66:67] op_sel_hi:[1,0,1] neg_lo:[1,0,0] neg_hi:[1,0,0]
    buffer_load_dwordx4 v[152:155], v3, s[20:23], s39 offen sc1
    v_pk_mul_f32 v[68:69], v[12:13], v[68:69]
    v_pk_mul_f32 v[70:71], v[14:15], v[70:71]
    v_pk_mul_f32 v[64:65], v[12:13], v[64:65]
    v_pk_mul_f32 v[66:67], v[14:15], v[66:67]
    ds_read_b128 v[8:11], v27 offset:384
    ds_read_b128 v[12:15], v27 offset:1408
    v_cvt_pk_bf16_f32 v120, v64, v65
    v_cvt_pk_bf16_f32 v121, v66, v67
    v_cvt_pk_bf16_f32 v124, v68, v69
    v_cvt_pk_bf16_f32 v125, v70, v71
    s_waitcnt lgkmcnt(2)
    v_pk_fma_f32 v[72:73], v[16:17], v[28:29], v[72:73] op_sel_hi:[1,0,1] neg_lo:[1,0,0] neg_hi:[1,0,0]
    v_pk_fma_f32 v[74:75], v[18:19], v[28:29], v[74:75] op_sel_hi:[1,0,1] neg_lo:[1,0,0] neg_hi:[1,0,0]
    s_add_u32 s39, s43, 20480
    buffer_load_dwordx4 v[156:159], v2, s[20:23], s39 offen offset:0 sc1
    v_pk_mul_f32 v[76:77], v[20:21], v[76:77]
    v_pk_mul_f32 v[78:79], v[22:23], v[78:79]
    v_pk_mul_f32 v[72:73], v[20:21], v[72:73]
    v_pk_mul_f32 v[74:75], v[22:23], v[74:75]
    ds_read_b128 v[16:19], v27 offset:448
    ds_read_b128 v[20:23], v27 offset:1472
    v_cvt_pk_bf16_f32 v122, v72, v73
    v_cvt_pk_bf16_f32 v123, v74, v75
    v_cvt_pk_bf16_f32 v126, v76, v77
    v_cvt_pk_bf16_f32 v127, v78, v79
    s_waitcnt lgkmcnt(2)
    v_pk_fma_f32 v[80:81], v[8:9], v[28:29], v[80:81] op_sel_hi:[1,0,1] neg_lo:[1,0,0] neg_hi:[1,0,0]
    v_pk_fma_f32 v[82:83], v[10:11], v[28:29], v[82:83] op_sel_hi:[1,0,1] neg_lo:[1,0,0] neg_hi:[1,0,0]
    buffer_load_dwordx4 v[160:163], v2, s[20:23], s39 offen offset:1024 sc1
    v_pk_mul_f32 v[84:85], v[12:13], v[84:85]
    v_pk_mul_f32 v[86:87], v[14:15], v[86:87]
    v_pk_mul_f32 v[80:81], v[12:13], v[80:81]
    v_pk_mul_f32 v[82:83], v[14:15], v[82:83]
    ds_read_b128 v[8:11], v26 offset:0
    ds_read_b128 v[12:15], v26 offset:1024
    v_cvt_pk_bf16_f32 v128, v80, v81
    v_cvt_pk_bf16_f32 v129, v82, v83
    v_cvt_pk_bf16_f32 v132, v84, v85
    v_cvt_pk_bf16_f32 v133, v86, v87
    s_waitcnt lgkmcnt(2)
    v_pk_fma_f32 v[88:89], v[16:17], v[28:29], v[88:89] op_sel_hi:[1,0,1] neg_lo:[1,0,0] neg_hi:[1,0,0]
    v_pk_fma_f32 v[90:91], v[18:19], v[28:29], v[90:91] op_sel_hi:[1,0,1] neg_lo:[1,0,0] neg_hi:[1,0,0]
    buffer_load_dwordx4 v[164:167], v2, s[20:23], s39 offen offset:2048 sc1
    v_pk_mul_f32 v[92:93], v[20:21], v[92:93]
    v_pk_mul_f32 v[94:95], v[22:23], v[94:95]
    v_pk_mul_f32 v[88:89], v[20:21], v[88:89]
    v_pk_mul_f32 v[90:91], v[22:23], v[90:91]
    ds_read_b128 v[16:19], v26 offset:4096
    ds_read_b128 v[20:23], v26 offset:5120
    v_cvt_pk_bf16_f32 v130, v88, v89
    v_cvt_pk_bf16_f32 v131, v90, v91
    v_cvt_pk_bf16_f32 v134, v92, v93
    v_cvt_pk_bf16_f32 v135, v94, v95
    s_nop 1
    v_mfma_f32_16x16x32_bf16 v[40:43], v[96:99], v[104:107], 0
    v_mfma_f32_16x16x32_bf16 v[44:47], v[96:99], v[108:111], 0
    v_mfma_f32_16x16x32_bf16 v[72:75], v[96:99], v[120:123], 0
    v_mfma_f32_16x16x32_bf16 v[76:79], v[96:99], v[124:127], 0
    buffer_load_dwordx4 v[168:171], v2, s[20:23], s39 offen offset:3072 sc1
    v_mfma_f32_16x16x32_bf16 v[40:43], v[100:103], v[112:115], v[40:43]
    v_mfma_f32_16x16x32_bf16 v[44:47], v[100:103], v[116:119], v[44:47]
    v_mfma_f32_16x16x32_bf16 v[72:75], v[100:103], v[128:131], v[72:75]
    v_mfma_f32_16x16x32_bf16 v[76:79], v[100:103], v[132:135], v[76:79]
    buffer_load_dwordx4 v[172:175], v3, s[20:23], s39 offen sc1
    ds_read_b128 v[96:99], v26 offset:6144
    ds_read_b128 v[100:103], v26 offset:7168
    s_waitcnt lgkmcnt(4)
    v_mfma_f32_16x16x32_bf16 v[32:35], v[8:11], v[104:107], 0
    v_mfma_f32_16x16x32_bf16 v[36:39], v[8:11], v[108:111], 0
    v_mfma_f32_16x16x32_bf16 v[64:67], v[8:11], v[120:123], 0
    v_mfma_f32_16x16x32_bf16 v[68:71], v[8:11], v[124:127], 0
    s_add_u32 s39, s43, 25600
    buffer_load_dwordx4 v[176:179], v2, s[20:23], s39 offen offset:0 sc1
    v_mfma_f32_16x16x32_bf16 v[32:35], v[12:15], v[112:115], v[32:35]
    v_mfma_f32_16x16x32_bf16 v[36:39], v[12:15], v[116:119], v[36:39]
    v_mfma_f32_16x16x32_bf16 v[64:67], v[12:15], v[128:131], v[64:67]
    v_mfma_f32_16x16x32_bf16 v[68:71], v[12:15], v[132:135], v[68:71]
    buffer_load_dwordx4 v[180:183], v2, s[20:23], s39 offen offset:1024 sc1
    s_waitcnt lgkmcnt(2)
    v_mfma_f32_16x16x32_bf16 v[48:51], v[16:19], v[104:107], 0
    v_mfma_f32_16x16x32_bf16 v[52:55], v[16:19], v[108:111], 0
    v_mfma_f32_16x16x32_bf16 v[80:83], v[16:19], v[120:123], 0
    v_mfma_f32_16x16x32_bf16 v[84:87], v[16:19], v[124:127], 0
    buffer_load_dwordx4 v[184:187], v2, s[20:23], s39 offen offset:2048 sc1
    v_mfma_f32_16x16x32_bf16 v[48:51], v[20:23], v[112:115], v[48:51]
    v_mfma_f32_16x16x32_bf16 v[52:55], v[20:23], v[116:119], v[52:55]
    v_mfma_f32_16x16x32_bf16 v[80:83], v[20:23], v[128:131], v[80:83]
    v_mfma_f32_16x16x32_bf16 v[84:87], v[20:23], v[132:135], v[84:87]
    buffer_load_dwordx4 v[188:191], v2, s[20:23], s39 offen offset:3072 sc1
    s_waitcnt lgkmcnt(0)
    v_mfma_f32_16x16x32_bf16 v[56:59], v[96:99], v[104:107], 0
    v_mfma_f32_16x16x32_bf16 v[60:63], v[96:99], v[108:111], 0
    v_mfma_f32_16x16x32_bf16 v[88:91], v[96:99], v[120:123], 0
    v_mfma_f32_16x16x32_bf16 v[92:95], v[96:99], v[124:127], 0
    buffer_load_dwordx4 v[192:195], v3, s[20:23], s39 offen sc1
    v_mfma_f32_16x16x32_bf16 v[56:59], v[100:103], v[112:115], v[56:59]
    v_mfma_f32_16x16x32_bf16 v[60:63], v[100:103], v[116:119], v[60:63]
    v_mfma_f32_16x16x32_bf16 v[88:91], v[100:103], v[128:131], v[88:91]
    v_mfma_f32_16x16x32_bf16 v[92:95], v[100:103], v[132:135], v[92:95]
    v_cvt_pk_bf16_f32 v104, v32, v48
    v_cvt_pk_bf16_f32 v8, v36, v52
    v_cvt_pk_bf16_f32 v106, v64, v80
    v_cvt_pk_bf16_f32 v9, v68, v84
    v_cndmask_b32 v105, v8, 0, s[70:71]
    v_cndmask_b32 v107, v9, 0, s[70:71]
    s_add_u32 s63, s62, 0
    buffer_store_dwordx4 v[104:107], v24, s[20:23], s63 offen sc1
    v_cvt_pk_bf16_f32 v108, v33, v49
    v_cvt_pk_bf16_f32 v10, v37, v53
    v_cvt_pk_bf16_f32 v110, v65, v81
    v_cvt_pk_bf16_f32 v11, v69, v85
    v_cndmask_b32 v109, v10, 0, s[70:71]
    v_cndmask_b32 v111, v11, 0, s[70:71]
    s_add_u32 s63, s62, 86016
    buffer_store_dwordx4 v[108:111], v24, s[20:23], s63 offen sc1
    v_cvt_pk_bf16_f32 v112, v34, v50
    v_cvt_pk_bf16_f32 v12, v38, v54
    v_cvt_pk_bf16_f32 v114, v66, v82
    v_cvt_pk_bf16_f32 v13, v70, v86
    v_cndmask_b32 v113, v12, 0, s[70:71]
    v_cndmask_b32 v115, v13, 0, s[70:71]
    s_add_u32 s63, s62, 172032
    buffer_store_dwordx4 v[112:115], v24, s[20:23], s63 offen sc1
    v_cvt_pk_bf16_f32 v116, v35, v51
    v_cvt_pk_bf16_f32 v14, v39, v55
    v_cvt_pk_bf16_f32 v118, v67, v83
    v_cvt_pk_bf16_f32 v15, v71, v87
    v_cndmask_b32 v117, v14, 0, s[70:71]
    v_cndmask_b32 v119, v15, 0, s[70:71]
    s_add_u32 s63, s62, 258048
    buffer_store_dwordx4 v[116:119], v24, s[20:23], s63 offen sc1
    s_nop 3
    v_cvt_pk_bf16_f32 v120, v40, v56
    v_cvt_pk_bf16_f32 v16, v44, v60
    v_cvt_pk_bf16_f32 v122, v72, v88
    v_cvt_pk_bf16_f32 v17, v76, v92
    v_cndmask_b32 v121, v16, 0, s[70:71]
    v_cndmask_b32 v123, v17, 0, s[70:71]
    s_add_u32 s63, s62, 1376256
    buffer_store_dwordx4 v[120:123], v24, s[20:23], s63 offen sc1
    v_cvt_pk_bf16_f32 v124, v41, v57
    v_cvt_pk_bf16_f32 v18, v45, v61
    v_cvt_pk_bf16_f32 v126, v73, v89
    v_cvt_pk_bf16_f32 v19, v77, v93
    v_cndmask_b32 v125, v18, 0, s[70:71]
    v_cndmask_b32 v127, v19, 0, s[70:71]
    s_add_u32 s63, s62, 1462272
    buffer_store_dwordx4 v[124:127], v24, s[20:23], s63 offen sc1
    v_cvt_pk_bf16_f32 v128, v42, v58
    v_cvt_pk_bf16_f32 v20, v46, v62
    v_cvt_pk_bf16_f32 v130, v74, v90
    v_cvt_pk_bf16_f32 v21, v78, v94
    v_cndmask_b32 v129, v20, 0, s[70:71]
    v_cndmask_b32 v131, v21, 0, s[70:71]
    s_add_u32 s63, s62, 1548288
    buffer_store_dwordx4 v[128:131], v24, s[20:23], s63 offen sc1
    v_cvt_pk_bf16_f32 v132, v43, v59
    v_cvt_pk_bf16_f32 v22, v47, v63
    v_cvt_pk_bf16_f32 v134, v75, v91
    v_cvt_pk_bf16_f32 v23, v79, v95
    v_cndmask_b32 v133, v22, 0, s[70:71]
    v_cndmask_b32 v135, v23, 0, s[70:71]
    s_add_u32 s63, s62, 1634304
    buffer_store_dwordx4 v[132:135], v24, s[20:23], s63 offen sc1
    s_cmp_eq_u32 s70, 0
    s_cbranch_scc1 K_nony
    s_mov_b64 exec, s[70:71]
    v_mov_b32 v32, v8
    v_mov_b32 v33, 0
    v_mov_b32 v34, v9
    v_mov_b32 v35, 0
    s_add_u32 s63, s62, 0
    buffer_store_dwordx4 v[32:35], v25, s[20:23], s63 offen sc1
    v_mov_b32 v36, v10
    v_mov_b32 v37, 0
    v_mov_b32 v38, v11
    v_mov_b32 v39, 0
    s_add_u32 s63, s62, 86016
    buffer_store_dwordx4 v[36:39], v25, s[20:23], s63 offen sc1
    v_mov_b32 v40, v12
    v_mov_b32 v41, 0
    v_mov_b32 v42, v13
    v_mov_b32 v43, 0
    s_add_u32 s63, s62, 172032
    buffer_store_dwordx4 v[40:43], v25, s[20:23], s63 offen sc1
    v_mov_b32 v44, v14
    v_mov_b32 v45, 0
    v_mov_b32 v46, v15
    v_mov_b32 v47, 0
    s_add_u32 s63, s62, 258048
    buffer_store_dwordx4 v[44:47], v25, s[20:23], s63 offen sc1
    v_mov_b32 v48, v16
    v_mov_b32 v49, 0
    v_mov_b32 v50, v17
    v_mov_b32 v51, 0
    s_add_u32 s63, s62, 1376256
    buffer_store_dwordx4 v[48:51], v25, s[20:23], s63 offen sc1
    v_mov_b32 v52, v18
    v_mov_b32 v53, 0
    v_mov_b32 v54, v19
    v_mov_b32 v55, 0
    s_add_u32 s63, s62, 1462272
    buffer_store_dwordx4 v[52:55], v25, s[20:23], s63 offen sc1
    v_mov_b32 v56, v20
    v_mov_b32 v57, 0
    v_mov_b32 v58, v21
    v_mov_b32 v59, 0
    s_add_u32 s63, s62, 1548288
    buffer_store_dwordx4 v[56:59], v25, s[20:23], s63 offen sc1
    v_mov_b32 v60, v22
    v_mov_b32 v61, 0
    v_mov_b32 v62, v23
    v_mov_b32 v63, 0
    s_add_u32 s63, s62, 1634304
    buffer_store_dwordx4 v[60:63], v25, s[20:23], s63 offen sc1
    s_mov_b64 exec, -1
K_nony:
    s_waitcnt vmcnt(0)
K_seam:
    s_barrier
    s_sub_u32 s34, 64, s40
    s_cmp_eq_u32 s40, 0
    s_cselect_b32 s34, 32, s34
    s_cmp_ge_u32 s41, 4
    s_cselect_b32 s36, 1, 0
    s_cmp_eq_u32 s28, 0
    s_cbranch_scc0 K_notw0a
    buffer_store_dwordx2 v[6:7], v31, s[20:23], s68 offen sc1
K_notw0a:
    s_cmp_eq_u32 s31, 1
    s_cbranch_scc1 K_seamF
    s_add_u32 s39, s43, 20480
    buffer_load_dwordx4 v[156:159], v2, s[20:23], s39 offen offset:0 sc1
    buffer_load_dwordx4 v[160:163], v2, s[20:23], s39 offen offset:1024 sc1
    buffer_load_dwordx4 v[164:167], v2, s[20:23], s39 offen offset:2048 sc1
    buffer_load_dwordx4 v[168:171], v2, s[20:23], s39 offen offset:3072 sc1
    buffer_load_dwordx4 v[172:175], v3, s[20:23], s39 offen sc1
    s_add_u32 s39, s43, 25600
    buffer_load_dwordx4 v[176:179], v2, s[20:23], s39 offen offset:0 sc1
    buffer_load_dwordx4 v[180:183], v2, s[20:23], s39 offen offset:1024 sc1
    buffer_load_dwordx4 v[184:187], v2, s[20:23], s39 offen offset:2048 sc1
    buffer_load_dwordx4 v[188:191], v2, s[20:23], s39 offen offset:3072 sc1
    buffer_load_dwordx4 v[192:195], v3, s[20:23], s39 offen sc1
K_seamF:
    s_cmp_ge_u32 s28, 6
    s_cbranch_scc1 K_now6
    s_add_u32 s39, s43, 30720
    s_mul_i32 s54, s28, 5120
    s_add_u32 s54, s54, 102400
    s_add_u32 m0, s54, 0
    s_nop 0
    buffer_load_dwordx4 v2, s[20:23], s39 offen offset:0 sc1 lds
    s_add_u32 m0, s54, 0
    s_nop 0
    buffer_load_dwordx4 v2, s[20:23], s39 offen offset:1024 sc1 lds
    s_add_u32 m0, s54, 0
    s_nop 0
    buffer_load_dwordx4 v2, s[20:23], s39 offen offset:2048 sc1 lds
    s_add_u32 m0, s54, 0
    s_nop 0
    buffer_load_dwordx4 v2, s[20:23], s39 offen offset:3072 sc1 lds
    s_add_u32 m0, s54, 4096
    s_nop 0
    buffer_load_dwordx4 v3, s[20:23], s39 offen offset:0 sc1 lds
K_now6:
    s_cmp_eq_u32 s28, 0
    s_cbranch_scc0 K_notw0
    s_lshl_b32 s54, s52, 5
    v_min_u32 v11, 26, v1
    v_add_u32 v11, s54, v11
    v_lshlrev_b32 v11, 8, v11
    s_mov_b32 s61, 15798272
    s_mov_b32 s63, 0
K_poll2:
    buffer_load_dwordx2 v[12:13], v11, s[20:23], s61 offen sc1
    s_add_u32 s63, s63, 1
    s_waitcnt vmcnt(0)
    v_cmp_ne_u64 vcc, s[72:73], v[12:13]
    s_cmp_gt_u32 s63, 131072
    s_cbranch_scc1 K_go2
    s_cbranch_vccnz K_poll2
    s_branch K_go2
K_notw0:
    v_lshlrev_b32 v8, 2, v1
    v_add_u32 v8, 143360, v8
    v_mov_b32 v9, 0
    ds_write_b32 v8, v9
    s_waitcnt lgkmcnt(0)
    s_cmp_ge_u32 s28, 6
    s_cbranch_scc0 K_go2
    s_sub_u32 s38, s28, 6
    s_lshl_b32 s39, s38, 13
    s_add_u32 s39, s39, 86016
    v_add_u32 v4, s39, v2
    s_lshl_b32 s38, s38, 3
    s_mul_i32 s37, s41, 80
    v_and_b32 v8, 15, v1
    v_add_u32 v9, s37, v8
    v_sub_u32 v10, 576, v9
    s_cmp_eq_u32 s36, 1
    s_cselect_b64 vcc, -1, 0
    v_lshrrev_b32 v11, 4, v1
    v_cndmask_b32 v9, v9, v10, vcc
    v_mul_u32_u24 v10, 336, v11
    v_add_u32 v9, v9, v10
    v_lshlrev_b32 v5, 4, v9
    s_lshl_b32 s39, s40, 4
    s_add_u32 s39, s39, s38
    s_mul_i32 s39, s39, 5376
    s_add_u32 s39, s39, 12582912
    s_mul_i32 s54, s41, 80
    s_sub_u32 s61, 561, s54
    s_cmp_eq_u32 s36, 1
    s_cselect_b32 s54, s61, s54
    s_lshr_b32 s54, s54, 6
    v_bfe_u32 v9, v1, 3, 2
    v_and_b32 v10, 7, v1
    v_add_u32 v11, s54, v9
    v_cmp_lt_u32 vcc, 1, v9
    v_add_u32 v11, 27, v11
    s_mov_b32 s61, 15798272
    v_cndmask_b32 v11, v11, 27, vcc
    v_lshl_add_u32 v11, v10, 5, v11
    v_lshlrev_b32 v1, 8, v11
    s_movk_i32 s54, 0
    s_cmp_eq_u32 s36, 1
    s_cselect_b32 s8, 1024, s54
    s_add_u32 s8, s8, s39
    s_movk_i32 s54, 256
    s_cmp_eq_u32 s36, 1
    s_cselect_b32 s9, 768, s54
    s_add_u32 s9, s9, s39
    s_movk_i32 s54, 512
    s_cmp_eq_u32 s36, 1
    s_cselect_b32 s10, 512, s54
    s_add_u32 s10, s10, s39
    s_movk_i32 s54, 768
    s_cmp_eq_u32 s36, 1
    s_cselect_b32 s11, 256, s54
    s_add_u32 s11, s11, s39
    s_movk_i32 s54, 1024
    s_cmp_eq_u32 s36, 1
    s_cselect_b32 s12, 0, s54
    s_add_u32 s12, s12, s39
K_go2:
    s_barrier
    s_add_u32 s54, s42, 0
    buffer_load_dwordx4 v[88:91], v2, s[20:23], s54 offen offset:0 sc1
    buffer_load_dwordx4 v[92:95], v2, s[20:23], s54 offen offset:1024 sc1
    buffer_load_dwordx4 v[96:99], v2, s[20:23], s54 offen offset:2048 sc1
    buffer_load_dwordx4 v[100:103], v2, s[20:23], s54 offen offset:3072 sc1
    s_barrier
    s_add_u32 s54, s42, 4096
    buffer_load_dwordx4 v[104:107], v2, s[20:23], s54 offen offset:0 sc1
    buffer_load_dwordx4 v[108:111], v2, s[20:23], s54 offen offset:1024 sc1
    buffer_load_dwordx4 v[112:115], v2, s[20:23], s54 offen offset:2048 sc1
    buffer_load_dwordx4 v[116:119], v2, s[20:23], s54 offen offset:3072 sc1
    s_cmp_ge_u32 s28, 6
    s_cbranch_scc1 K_p2dft
    s_waitcnt vmcnt(4)
    v_mfma_f32_16x16x32_bf16 v[8:11], v[196:199], v[88:91], 0
    v_mfma_f32_16x16x32_bf16 v[12:15], v[200:203], v[88:91], 0
    s_add_u32 s54, s42, 8192
    buffer_load_dwordx4 v[120:123], v2, s[20:23], s54 offen offset:0 sc1
    v_mfma_f32_16x16x32_bf16 v[16:19], v[204:207], v[88:91], 0
    v_mfma_f32_16x16x32_bf16 v[20:23], v[208:211], v[88:91], 0
    v_mfma_f32_16x16x32_bf16 v[24:27], v[212:215], v[88:91], 0
    v_mfma_f32_16x16x32_bf16 v[44:47], v[212:215], v[92:95], 0
    buffer_load_dwordx4 v[124:127], v2, s[20:23], s54 offen offset:1024 sc1
    v_mfma_f32_16x16x32_bf16 v[40:43], v[208:211], v[92:95], 0
    v_mfma_f32_16x16x32_bf16 v[36:39], v[204:207], v[92:95], 0
    v_mfma_f32_16x16x32_bf16 v[32:35], v[200:203], v[92:95], 0
    v_mfma_f32_16x16x32_bf16 v[28:31], v[196:199], v[92:95], 0
    v_mfma_f32_16x16x32_bf16 v[48:51], v[196:199], v[96:99], 0
    buffer_load_dwordx4 v[128:131], v2, s[20:23], s54 offen offset:2048 sc1
    v_mfma_f32_16x16x32_bf16 v[52:55], v[200:203], v[96:99], 0
    v_mfma_f32_16x16x32_bf16 v[56:59], v[204:207], v[96:99], 0
    v_mfma_f32_16x16x32_bf16 v[60:63], v[208:211], v[96:99], 0
    v_mfma_f32_16x16x32_bf16 v[64:67], v[212:215], v[96:99], 0
    buffer_load_dwordx4 v[132:135], v2, s[20:23], s54 offen offset:3072 sc1
    v_mfma_f32_16x16x32_bf16 v[84:87], v[212:215], v[100:103], 0
    v_mfma_f32_16x16x32_bf16 v[80:83], v[208:211], v[100:103], 0
    v_mfma_f32_16x16x32_bf16 v[76:79], v[204:207], v[100:103], 0
    v_mfma_f32_16x16x32_bf16 v[72:75], v[200:203], v[100:103], 0
    v_mfma_f32_16x16x32_bf16 v[68:71], v[196:199], v[100:103], 0
    s_waitcnt vmcnt(4)
    v_mfma_f32_16x16x32_bf16 v[8:11], v[216:219], v[104:107], v[8:11]
    v_mfma_f32_16x16x32_bf16 v[12:15], v[220:223], v[104:107], v[12:15]
    s_add_u32 s54, s42, 12288
    buffer_load_dwordx4 v[88:91], v2, s[20:23], s54 offen offset:0 sc1
    v_mfma_f32_16x16x32_bf16 v[16:19], v[224:227], v[104:107], v[16:19]
    v_mfma_f32_16x16x32_bf16 v[20:23], v[228:231], v[104:107], v[20:23]
    v_mfma_f32_16x16x32_bf16 v[24:27], v[232:235], v[104:107], v[24:27]
    buffer_load_dwordx4 v[92:95], v2, s[20:23], s54 offen offset:1024 sc1
    v_mfma_f32_16x16x32_bf16 v[44:47], v[232:235], v[108:111], v[44:47]
    v_mfma_f32_16x16x32_bf16 v[40:43], v[228:231], v[108:111], v[40:43]
    v_mfma_f32_16x16x32_bf16 v[36:39], v[224:227], v[108:111], v[36:39]
    v_mfma_f32_16x16x32_bf16 v[32:35], v[220:223], v[108:111], v[32:35]
    buffer_load_dwordx4 v[96:99], v2, s[20:23], s54 offen offset:2048 sc1
    v_mfma_f32_16x16x32_bf16 v[28:31], v[216:219], v[108:111], v[28:31]
    v_mfma_f32_16x16x32_bf16 v[48:51], v[216:219], v[112:115], v[48:51]
    v_mfma_f32_16x16x32_bf16 v[52:55], v[220:223], v[112:115], v[52:55]
    buffer_load_dwordx4 v[100:103], v2, s[20:23], s54 offen offset:3072 sc1
    v_mfma_f32_16x16x32_bf16 v[56:59], v[224:227], v[112:115], v[56:59]
    v_mfma_f32_16x16x32_bf16 v[60:63], v[228:231], v[112:115], v[60:63]
    v_mfma_f32_16x16x32_bf16 v[64:67], v[232:235], v[112:115], v[64:67]
    v_mfma_f32_16x16x32_bf16 v[84:87], v[232:235], v[116:119], v[84:87]
    s_mul_i32 s39, s28, 5120
    s_add_u32 s39, s39, 102400
    v_add_u32 v4, s39, v2
    ds_read_b128 v[196:199], v4 offset:0
    ds_read_b128 v[200:203], v4 offset:1024
    ds_read_b128 v[204:207], v4 offset:2048
    ds_read_b128 v[208:211], v4 offset:3072
    ds_read_b128 v[212:215], v4 offset:4096
    v_mfma_f32_16x16x32_bf16 v[80:83], v[228:231], v[116:119], v[80:83]
    v_mfma_f32_16x16x32_bf16 v[76:79], v[224:227], v[116:119], v[76:79]
    v_mfma_f32_16x16x32_bf16 v[72:75], v[220:223], v[116:119], v[72:75]
    v_mfma_f32_16x16x32_bf16 v[68:71], v[216:219], v[116:119], v[68:71]
    s_waitcnt vmcnt(4)
    v_mfma_f32_16x16x32_bf16 v[8:11], v[236:239], v[120:123], v[8:11]
    v_mfma_f32_16x16x32_bf16 v[12:15], v[240:243], v[120:123], v[12:15]
    s_add_u32 s54, s42, 16384
    buffer_load_dwordx4 v[104:107], v2, s[20:23], s54 offen offset:0 sc1
    v_mfma_f32_16x16x32_bf16 v[16:19], v[244:247], v[120:123], v[16:19]
    v_mfma_f32_16x16x32_bf16 v[20:23], v[248:251], v[120:123], v[20:23]
    v_mfma_f32_16x16x32_bf16 v[24:27], v[252:255], v[120:123], v[24:27]
    v_mfma_f32_16x16x32_bf16 v[44:47], v[252:255], v[124:127], v[44:47]
    buffer_load_dwordx4 v[108:111], v2, s[20:23], s54 offen offset:1024 sc1
    v_mfma_f32_16x16x32_bf16 v[40:43], v[248:251], v[124:127], v[40:43]
    v_mfma_f32_16x16x32_bf16 v[36:39], v[244:247], v[124:127], v[36:39]
    v_mfma_f32_16x16x32_bf16 v[32:35], v[240:243], v[124:127], v[32:35]
    v_mfma_f32_16x16x32_bf16 v[28:31], v[236:239], v[124:127], v[28:31]
    v_mfma_f32_16x16x32_bf16 v[48:51], v[236:239], v[128:131], v[48:51]
    buffer_load_dwordx4 v[112:115], v2, s[20:23], s54 offen offset:2048 sc1
    v_mfma_f32_16x16x32_bf16 v[52:55], v[240:243], v[128:131], v[52:55]
    v_mfma_f32_16x16x32_bf16 v[56:59], v[244:247], v[128:131], v[56:59]
    v_mfma_f32_16x16x32_bf16 v[60:63], v[248:251], v[128:131], v[60:63]
    v_mfma_f32_16x16x32_bf16 v[64:67], v[252:255], v[128:131], v[64:67]
    buffer_load_dwordx4 v[116:119], v2, s[20:23], s54 offen offset:3072 sc1
    v_mfma_f32_16x16x32_bf16 v[84:87], v[252:255], v[132:135], v[84:87]
    v_mfma_f32_16x16x32_bf16 v[80:83], v[248:251], v[132:135], v[80:83]
    v_mfma_f32_16x16x32_bf16 v[76:79], v[244:247], v[132:135], v[76:79]
    v_mfma_f32_16x16x32_bf16 v[72:75], v[240:243], v[132:135], v[72:75]
    v_mfma_f32_16x16x32_bf16 v[68:71], v[236:239], v[132:135], v[68:71]
    s_waitcnt vmcnt(4)
    v_mfma_f32_16x16x32_bf16 v[8:11], v[136:139], v[88:91], v[8:11]
    v_mfma_f32_16x16x32_bf16 v[12:15], v[140:143], v[88:91], v[12:15]
    s_add_u32 s54, s42, 20480
    buffer_load_dwordx4 v[120:123], v2, s[20:23], s54 offen offset:0 sc1
    v_mfma_f32_16x16x32_bf16 v[16:19], v[144:147], v[88:91], v[16:19]
    v_mfma_f32_16x16x32_bf16 v[20:23], v[148:151], v[88:91], v[20:23]
    v_mfma_f32_16x16x32_bf16 v[24:27], v[152:155], v[88:91], v[24:27]
    buffer_load_dwordx4 v[124:127], v2, s[20:23], s54 offen offset:1024 sc1
    v_mfma_f32_16x16x32_bf16 v[44:47], v[152:155], v[92:95], v[44:47]
    v_mfma_f32_16x16x32_bf16 v[40:43], v[148:151], v[92:95], v[40:43]
    v_mfma_f32_16x16x32_bf16 v[36:39], v[144:147], v[92:95], v[36:39]
    buffer_load_dwordx4 v[128:131], v2, s[20:23], s54 offen offset:2048 sc1
    v_mfma_f32_16x16x32_bf16 v[32:35], v[140:143], v[92:95], v[32:35]
    v_mfma_f32_16x16x32_bf16 v[28:31], v[136:139], v[92:95], v[28:31]
    v_mfma_f32_16x16x32_bf16 v[48:51], v[136:139], v[96:99], v[48:51]
    buffer_load_dwordx4 v[132:135], v2, s[20:23], s54 offen offset:3072 sc1
    v_mfma_f32_16x16x32_bf16 v[52:55], v[140:143], v[96:99], v[52:55]
    v_mfma_f32_16x16x32_bf16 v[56:59], v[144:147], v[96:99], v[56:59]
    v_mfma_f32_16x16x32_bf16 v[60:63], v[148:151], v[96:99], v[60:63]
    s_add_u32 s54, s42, 24576
    buffer_load_dwordx4 v[216:219], v2, s[20:23], s54 offen offset:0 sc1
    v_mfma_f32_16x16x32_bf16 v[64:67], v[152:155], v[96:99], v[64:67]
    v_mfma_f32_16x16x32_bf16 v[84:87], v[152:155], v[100:103], v[84:87]
    v_mfma_f32_16x16x32_bf16 v[80:83], v[148:151], v[100:103], v[80:83]
    buffer_load_dwordx4 v[220:223], v2, s[20:23], s54 offen offset:1024 sc1
    v_mfma_f32_16x16x32_bf16 v[76:79], v[144:147], v[100:103], v[76:79]
    v_mfma_f32_16x16x32_bf16 v[72:75], v[140:143], v[100:103], v[72:75]
    v_mfma_f32_16x16x32_bf16 v[68:71], v[136:139], v[100:103], v[68:71]
    s_waitcnt vmcnt(6)
    v_mfma_f32_16x16x32_bf16 v[8:11], v[156:159], v[104:107], v[8:11]
    v_mfma_f32_16x16x32_bf16 v[12:15], v[160:163], v[104:107], v[12:15]
    s_add_u32 s54, s42, 24576
    buffer_load_dwordx4 v[224:227], v2, s[20:23], s54 offen offset:2048 sc1
    v_mfma_f32_16x16x32_bf16 v[16:19], v[164:167], v[104:107], v[16:19]
    v_mfma_f32_16x16x32_bf16 v[20:23], v[168:171], v[104:107], v[20:23]
    v_mfma_f32_16x16x32_bf16 v[24:27], v[172:175], v[104:107], v[24:27]
    v_mfma_f32_16x16x32_bf16 v[44:47], v[172:175], v[108:111], v[44:47]
    buffer_load_dwordx4 v[228:231], v2, s[20:23], s54 offen offset:3072 sc1
    v_mfma_f32_16x16x32_bf16 v[40:43], v[168:171], v[108:111], v[40:43]
    v_mfma_f32_16x16x32_bf16 v[36:39], v[164:167], v[108:111], v[36:39]
    v_mfma_f32_16x16x32_bf16 v[32:35], v[160:163], v[108:111], v[32:35]
    v_mfma_f32_16x16x32_bf16 v[28:31], v[156:159], v[108:111], v[28:31]
    v_mfma_f32_16x16x32_bf16 v[48:51], v[156:159], v[112:115], v[48:51]
    s_mov_b32 s24, s4
    s_mov_b32 s25, s5
    s_mov_b32 s26, 2621440
    s_mov_b32 s27, 0x00020000
    s_mul_i32 s33, s41, 160
    v_add_u32 v236, 0, v0
    v_mul_u32_u24 v237, 6554, v236
    v_lshrrev_b32 v237, 16, v237
    v_mul_u32_u24 v238, 10, v237
    v_sub_u32 v238, v236, v238
    v_mul_u32_u24 v234, 336, v237
    v_lshl_add_u32 v234, v238, 5, v234
    v_mov_b32 v239, s40
    v_mov_b32 v240, s34
    v_cmp_gt_u32 vcc, 32, v237
    v_and_b32 v241, 31, v237
    s_nop 0
    v_cndmask_b32 v239, v240, v239, vcc
    v_lshl_add_u32 v239, v241, 6, v239
    v_mul_u32_u24 v239, 1280, v239
    v_lshl_add_u32 v239, v238, 4, v239
    v_add_u32 v232, s33, v239
    v_add_u32 v236, 512, v0
    v_mul_u32_u24 v237, 6554, v236
    v_lshrrev_b32 v237, 16, v237
    v_mul_u32_u24 v238, 10, v237
    v_sub_u32 v238, v236, v238
    v_mul_u32_u24 v235, 336, v237
    v_lshl_add_u32 v235, v238, 5, v235
    v_mov_b32 v239, s40
    v_mov_b32 v240, s34
    v_cmp_gt_u32 vcc, 32, v237
    v_and_b32 v241, 31, v237
    s_nop 0
    v_cndmask_b32 v239, v240, v239, vcc
    v_lshl_add_u32 v239, v241, 6, v239
    v_mul_u32_u24 v239, 1280, v239
    v_lshl_add_u32 v239, v238, 4, v239
    v_add_u32 v233, s33, v239
    v_cmp_gt_u32 vcc, 128, v0
    v_mov_b32 v240, 2146435072
    s_nop 0
    v_cndmask_b32 v233, v240, v233, vcc
    v_mfma_f32_16x16x32_bf16 v[52:55], v[160:163], v[112:115], v[52:55]
    v_mfma_f32_16x16x32_bf16 v[56:59], v[164:167], v[112:115], v[56:59]
    v_mfma_f32_16x16x32_bf16 v[60:63], v[168:171], v[112:115], v[60:63]
    v_mfma_f32_16x16x32_bf16 v[64:67], v[172:175], v[112:115], v[64:67]
    s_and_b32 s39, s28, 3
    s_lshl_b32 s38, s39, 4
    s_add_u32 s38, s38, 143360
    v_mov_b32 v1, s38
    s_mul_i32 s39, s39, 21504
    v_add_u32 v3, s39, v2
    v_and_b32 v7, 15, v0
    v_mul_u32_u24 v7, 336, v7
    v_bfe_u32 v6, v0, 4, 2
    v_lshl_add_u32 v7, v6, 4, v7
    v_add_u32 v7, s39, v7
    v_mov_b32 v6, 1
    s_mov_b32 s80, s50
    s_mov_b32 s81, s51
    s_mov_b32 s82, 2621440
    s_mov_b32 s83, 0x00020000
    s_lshl_b32 s38, s28, 10
    s_add_u32 m0, s38, 133120
    s_cmp_ge_u32 s28, 2
    buffer_load_dwordx4 v232, s[24:27], 0 offen lds
    s_cbranch_scc1 K_nox2_1
    s_add_u32 m0, s38, 141312
    s_nop 0
    buffer_load_dwordx4 v233, s[24:27], 0 offen lds
K_nox2_1:
    v_mfma_f32_16x16x32_bf16 v[84:87], v[172:175], v[116:119], v[84:87]
    v_mfma_f32_16x16x32_bf16 v[80:83], v[168:171], v[116:119], v[80:83]
    v_mfma_f32_16x16x32_bf16 v[76:79], v[164:167], v[116:119], v[76:79]
    v_mfma_f32_16x16x32_bf16 v[72:75], v[160:163], v[116:119], v[72:75]
    v_mfma_f32_16x16x32_bf16 v[68:71], v[156:159], v[116:119], v[68:71]
    s_waitcnt vmcnt(1) lgkmcnt(0)
    s_cmp_ge_u32 s28, 4
    s_cbranch_scc1 K_p2y1
    v_mfma_f32_16x16x32_bf16 v[8:11], v[176:179], v[120:123], v[8:11]
    v_mfma_f32_16x16x32_bf16 v[12:15], v[180:183], v[120:123], v[12:15]
    v_mfma_f32_16x16x32_bf16 v[16:19], v[184:187], v[120:123], v[16:19]
    v_mfma_f32_16x16x32_bf16 v[20:23], v[188:191], v[120:123], v[20:23]
    v_mfma_f32_16x16x32_bf16 v[24:27], v[192:195], v[120:123], v[24:27]
    v_mfma_f32_16x16x32_bf16 v[24:27], v[212:215], v[216:219], v[24:27]
    v_mfma_f32_16x16x32_bf16 v[20:23], v[208:211], v[216:219], v[20:23]
    v_mfma_f32_16x16x32_bf16 v[16:19], v[204:207], v[216:219], v[16:19]
    v_mfma_f32_16x16x32_bf16 v[12:15], v[200:203], v[216:219], v[12:15]
    v_mfma_f32_16x16x32_bf16 v[8:11], v[196:199], v[216:219], v[8:11]
    v_mfma_f32_16x16x32_bf16 v[28:31], v[176:179], v[124:127], v[28:31]
    v_mfma_f32_16x16x32_bf16 v[32:35], v[180:183], v[124:127], v[32:35]
    v_mfma_f32_16x16x32_bf16 v[36:39], v[184:187], v[124:127], v[36:39]
    v_mfma_f32_16x16x32_bf16 v[40:43], v[188:191], v[124:127], v[40:43]
    v_mfma_f32_16x16x32_bf16 v[44:47], v[192:195], v[124:127], v[44:47]
    ds_write_b128 v3, v[24:27] offset:4096
    v_mfma_f32_16x16x32_bf16 v[44:47], v[212:215], v[220:223], v[44:47]
    ds_write_b128 v3, v[20:23] offset:3072
    v_mfma_f32_16x16x32_bf16 v[40:43], v[208:211], v[220:223], v[40:43]
    ds_write_b128 v3, v[16:19] offset:2048
    v_mfma_f32_16x16x32_bf16 v[36:39], v[204:207], v[220:223], v[36:39]
    ds_write_b128 v3, v[12:15] offset:1024
    v_mfma_f32_16x16x32_bf16 v[32:35], v[200:203], v[220:223], v[32:35]
    ds_write_b128 v3, v[8:11] offset:0
    v_mfma_f32_16x16x32_bf16 v[28:31], v[196:199], v[220:223], v[28:31]
    s_waitcnt lgkmcnt(0)
    ds_write_b32 v1, v6 offset:0
    v_mfma_f32_16x16x32_bf16 v[48:51], v[176:179], v[128:131], v[48:51]
    v_mfma_f32_16x16x32_bf16 v[52:55], v[180:183], v[128:131], v[52:55]
    v_mfma_f32_16x16x32_bf16 v[56:59], v[184:187], v[128:131], v[56:59]
    v_mfma_f32_16x16x32_bf16 v[60:63], v[188:191], v[128:131], v[60:63]
    v_mfma_f32_16x16x32_bf16 v[64:67], v[192:195], v[128:131], v[64:67]
    ds_write_b128 v3, v[44:47] offset:9472
    v_mfma_f32_16x16x32_bf16 v[64:67], v[212:215], v[224:227], v[64:67]
    ds_write_b128 v3, v[40:43] offset:8448
    v_mfma_f32_16x16x32_bf16 v[60:63], v[208:211], v[224:227], v[60:63]
    ds_write_b128 v3, v[36:39] offset:7424
    v_mfma_f32_16x16x32_bf16 v[56:59], v[204:207], v[224:227], v[56:59]
    ds_write_b128 v3, v[32:35] offset:6400
    v_mfma_f32_16x16x32_bf16 v[52:55], v[200:203], v[224:227], v[52:55]
    ds_write_b128 v3, v[28:31] offset:5376
    v_mfma_f32_16x16x32_bf16 v[48:51], v[196:199], v[224:227], v[48:51]
    s_waitcnt lgkmcnt(0)
    ds_write_b32 v1, v6 offset:4
    v_mfma_f32_16x16x32_bf16 v[68:71], v[176:179], v[132:135], v[68:71]
    v_mfma_f32_16x16x32_bf16 v[72:75], v[180:183], v[132:135], v[72:75]
    v_mfma_f32_16x16x32_bf16 v[76:79], v[184:187], v[132:135], v[76:79]
    v_mfma_f32_16x16x32_bf16 v[80:83], v[188:191], v[132:135], v[80:83]
    v_mfma_f32_16x16x32_bf16 v[84:87], v[192:195], v[132:135], v[84:87]
    ds_write_b128 v3, v[64:67] offset:14848
    v_mfma_f32_16x16x32_bf16 v[84:87], v[212:215], v[228:231], v[84:87]
    ds_write_b128 v3, v[60:63] offset:13824
    v_mfma_f32_16x16x32_bf16 v[80:83], v[208:211], v[228:231], v[80:83]
    ds_write_b128 v3, v[56:59] offset:12800
    v_mfma_f32_16x16x32_bf16 v[76:79], v[204:207], v[228:231], v[76:79]
    ds_write_b128 v3, v[52:55] offset:11776
    v_mfma_f32_16x16x32_bf16 v[72:75], v[200:203], v[228:231], v[72:75]
    ds_write_b128 v3, v[48:51] offset:10752
    v_mfma_f32_16x16x32_bf16 v[68:71], v[196:199], v[228:231], v[68:71]
    s_waitcnt lgkmcnt(0)
    ds_write_b32 v1, v6 offset:8
    s_nop 7
    s_waitcnt lgkmcnt(0)
    ds_write_b128 v3, v[84:87] offset:20224
    ds_write_b128 v3, v[80:83] offset:19200
    ds_write_b128 v3, v[76:79] offset:18176
    ds_write_b128 v3, v[72:75] offset:17152
    ds_write_b128 v3, v[68:71] offset:16128
    s_waitcnt lgkmcnt(0)
    ds_write_b32 v1, v6 offset:12
    s_waitcnt lgkmcnt(0)
    s_branch K_fin
K_p2y1:
K_lpA0:
    ds_read_b32 v6, v1 offset:0
    s_waitcnt lgkmcnt(0)
    v_readfirstlane_b32 s39, v6
    s_nop 0
    s_cmp_eq_u32 s39, 0
    s_cbranch_scc1 K_lpA0
K_lqA0:
    s_nop 1
    ds_read_b128 v[236:239], v3 offset:0
    ds_read_b128 v[240:243], v3 offset:1024
    ds_read_b128 v[244:247], v3 offset:2048
    ds_read_b128 v[248:251], v3 offset:3072
    ds_read_b128 v[252:255], v3 offset:4096
    ds_read_b32 v6, v1 offset:4
    v_mfma_f32_16x16x32_bf16 v[8:11], v[176:179], v[120:123], v[8:11]
    v_mfma_f32_16x16x32_bf16 v[12:15], v[180:183], v[120:123], v[12:15]
    v_mfma_f32_16x16x32_bf16 v[16:19], v[184:187], v[120:123], v[16:19]
    v_mfma_f32_16x16x32_bf16 v[20:23], v[188:191], v[120:123], v[20:23]
    v_mfma_f32_16x16x32_bf16 v[24:27], v[192:195], v[120:123], v[24:27]
    v_mfma_f32_16x16x32_bf16 v[24:27], v[212:215], v[216:219], v[24:27]
    v_mfma_f32_16x16x32_bf16 v[20:23], v[208:211], v[216:219], v[20:23]
    v_mfma_f32_16x16x32_bf16 v[16:19], v[204:207], v[216:219], v[16:19]
    v_mfma_f32_16x16x32_bf16 v[12:15], v[200:203], v[216:219], v[12:15]
    v_mfma_f32_16x16x32_bf16 v[8:11], v[196:199], v[216:219], v[8:11]
    s_waitcnt lgkmcnt(0)
    v_readfirstlane_b32 s39, v6
    s_nop 0
    s_cmp_lg_u32 s39, 0
    s_cbranch_scc1 K_lqA1
K_lpA1:
    ds_read_b32 v6, v1 offset:4
    s_waitcnt lgkmcnt(0)
    v_readfirstlane_b32 s39, v6
    s_nop 0
    s_cmp_eq_u32 s39, 0
    s_cbranch_scc1 K_lpA1
K_lqA1:
    s_nop 1
    ds_read_b128 v[136:139], v3 offset:5376
    ds_read_b128 v[140:143], v3 offset:6400
    ds_read_b128 v[144:147], v3 offset:7424
    ds_read_b128 v[148:151], v3 offset:8448
    ds_read_b128 v[152:155], v3 offset:9472
    ds_read_b32 v6, v1 offset:8
    v_mfma_f32_16x16x32_bf16 v[28:31], v[176:179], v[124:127], v[28:31]
    v_add_f32 v8, v8, v236
    v_add_f32 v9, v9, v237
    v_mfma_f32_16x16x32_bf16 v[32:35], v[180:183], v[124:127], v[32:35]
    v_add_f32 v10, v10, v238
    v_add_f32 v11, v11, v239
    ds_write_b128 v7, v[8:11] offset:0
    v_mfma_f32_16x16x32_bf16 v[36:39], v[184:187], v[124:127], v[36:39]
    v_add_f32 v12, v12, v240
    v_add_f32 v13, v13, v241
    v_mfma_f32_16x16x32_bf16 v[40:43], v[188:191], v[124:127], v[40:43]
    v_add_f32 v14, v14, v242
    v_add_f32 v15, v15, v243
    ds_write_b128 v7, v[12:15] offset:64
    v_mfma_f32_16x16x32_bf16 v[44:47], v[192:195], v[124:127], v[44:47]
    v_add_f32 v16, v16, v244
    v_add_f32 v17, v17, v245
    v_mfma_f32_16x16x32_bf16 v[44:47], v[212:215], v[220:223], v[44:47]
    v_add_f32 v18, v18, v246
    v_add_f32 v19, v19, v247
    ds_write_b128 v7, v[16:19] offset:128
    v_mfma_f32_16x16x32_bf16 v[40:43], v[208:211], v[220:223], v[40:43]
    v_add_f32 v20, v20, v248
    v_add_f32 v21, v21, v249
    v_mfma_f32_16x16x32_bf16 v[36:39], v[204:207], v[220:223], v[36:39]
    v_add_f32 v22, v22, v250
    v_add_f32 v23, v23, v251
    ds_write_b128 v7, v[20:23] offset:192
    v_mfma_f32_16x16x32_bf16 v[32:35], v[200:203], v[220:223], v[32:35]
    v_add_f32 v24, v24, v252
    v_add_f32 v25, v25, v253
    v_mfma_f32_16x16x32_bf16 v[28:31], v[196:199], v[220:223], v[28:31]
    v_add_f32 v26, v26, v254
    v_add_f32 v27, v27, v255
    ds_write_b128 v7, v[24:27] offset:256
    s_waitcnt lgkmcnt(5)
    v_readfirstlane_b32 s39, v6
    s_nop 0
    s_cmp_lg_u32 s39, 0
    s_cbranch_scc1 K_lqA2
K_lpA2:
    ds_read_b32 v6, v1 offset:8
    s_waitcnt lgkmcnt(0)
    v_readfirstlane_b32 s39, v6
    s_nop 0
    s_cmp_eq_u32 s39, 0
    s_cbranch_scc1 K_lpA2
K_lqA2:
    s_nop 1
    ds_read_b128 v[236:239], v3 offset:10752
    ds_read_b128 v[240:243], v3 offset:11776
    ds_read_b128 v[244:247], v3 offset:12800
    ds_read_b128 v[248:251], v3 offset:13824
    ds_read_b128 v[252:255], v3 offset:14848
    ds_read_b32 v6, v1 offset:12
    v_mfma_f32_16x16x32_bf16 v[48:51], v[176:179], v[128:131], v[48:51]
    v_add_f32 v28, v28, v136
    v_add_f32 v29, v29, v137
    v_mfma_f32_16x16x32_bf16 v[52:55], v[180:183], v[128:131], v[52:55]
    v_add_f32 v30, v30, v138
    v_add_f32 v31, v31, v139
    ds_write_b128 v7, v[28:31] offset:5376
    v_mfma_f32_16x16x32_bf16 v[56:59], v[184:187], v[128:131], v[56:59]
    v_add_f32 v32, v32, v140
    v_add_f32 v33, v33, v141
    v_mfma_f32_16x16x32_bf16 v[60:63], v[188:191], v[128:131], v[60:63]
    v_add_f32 v34, v34, v142
    v_add_f32 v35, v35, v143
    ds_write_b128 v7, v[32:35] offset:5440
    v_mfma_f32_16x16x32_bf16 v[64:67], v[192:195], v[128:131], v[64:67]
    v_add_f32 v36, v36, v144
    v_add_f32 v37, v37, v145
    v_mfma_f32_16x16x32_bf16 v[64:67], v[212:215], v[224:227], v[64:67]
    v_add_f32 v38, v38, v146
    v_add_f32 v39, v39, v147
    ds_write_b128 v7, v[36:39] offset:5504
    v_mfma_f32_16x16x32_bf16 v[60:63], v[208:211], v[224:227], v[60:63]
    v_add_f32 v40, v40, v148
    v_add_f32 v41, v41, v149
    v_mfma_f32_16x16x32_bf16 v[56:59], v[204:207], v[224:227], v[56:59]
    v_add_f32 v42, v42, v150
    v_add_f32 v43, v43, v151
    ds_write_b128 v7, v[40:43] offset:5568
    v_mfma_f32_16x16x32_bf16 v[52:55], v[200:203], v[224:227], v[52:55]
    v_add_f32 v44, v44, v152
    v_add_f32 v45, v45, v153
    v_mfma_f32_16x16x32_bf16 v[48:51], v[196:199], v[224:227], v[48:51]
    v_add_f32 v46, v46, v154
    v_add_f32 v47, v47, v155
    ds_write_b128 v7, v[44:47] offset:5632
    s_waitcnt lgkmcnt(5)
    v_readfirstlane_b32 s39, v6
    s_nop 0
    s_cmp_lg_u32 s39, 0
    s_cbranch_scc1 K_lqA3
K_lpA3:
    ds_read_b32 v6, v1 offset:12
    s_waitcnt lgkmcnt(0)
    v_readfirstlane_b32 s39, v6
    s_nop 0
    s_cmp_eq_u32 s39, 0
    s_cbranch_scc1 K_lpA3
K_lqA3:
    s_nop 1
    ds_read_b128 v[136:139], v3 offset:16128
    ds_read_b128 v[140:143], v3 offset:17152
    ds_read_b128 v[144:147], v3 offset:18176
    ds_read_b128 v[148:151], v3 offset:19200
    ds_read_b128 v[152:155], v3 offset:20224
    v_mfma_f32_16x16x32_bf16 v[68:71], v[176:179], v[132:135], v[68:71]
    v_add_f32 v48, v48, v236
    v_add_f32 v49, v49, v237
    v_mfma_f32_16x16x32_bf16 v[72:75], v[180:183], v[132:135], v[72:75]
    v_add_f32 v50, v50, v238
    v_add_f32 v51, v51, v239
    ds_write_b128 v7, v[48:51] offset:10752
    v_mfma_f32_16x16x32_bf16 v[76:79], v[184:187], v[132:135], v[76:79]
    v_add_f32 v52, v52, v240
    v_add_f32 v53, v53, v241
    v_mfma_f32_16x16x32_bf16 v[80:83], v[188:191], v[132:135], v[80:83]
    v_add_f32 v54, v54, v242
    v_add_f32 v55, v55, v243
    ds_write_b128 v7, v[52:55] offset:10816
    v_mfma_f32_16x16x32_bf16 v[84:87], v[192:195], v[132:135], v[84:87]
    v_add_f32 v56, v56, v244
    v_add_f32 v57, v57, v245
    v_mfma_f32_16x16x32_bf16 v[84:87], v[212:215], v[228:231], v[84:87]
    v_add_f32 v58, v58, v246
    v_add_f32 v59, v59, v247
    ds_write_b128 v7, v[56:59] offset:10880
    v_mfma_f32_16x16x32_bf16 v[80:83], v[208:211], v[228:231], v[80:83]
    v_add_f32 v60, v60, v248
    v_add_f32 v61, v61, v249
    v_mfma_f32_16x16x32_bf16 v[76:79], v[204:207], v[228:231], v[76:79]
    v_add_f32 v62, v62, v250
    v_add_f32 v63, v63, v251
    ds_write_b128 v7, v[60:63] offset:10944
    v_mfma_f32_16x16x32_bf16 v[72:75], v[200:203], v[228:231], v[72:75]
    v_add_f32 v64, v64, v252
    v_add_f32 v65, v65, v253
    v_mfma_f32_16x16x32_bf16 v[68:71], v[196:199], v[228:231], v[68:71]
    v_add_f32 v66, v66, v254
    v_add_f32 v67, v67, v255
    ds_write_b128 v7, v[64:67] offset:11008
    s_nop 7
    s_waitcnt lgkmcnt(0)
    v_pk_add_f32 v[68:69], v[68:69], v[136:137]
    v_pk_add_f32 v[70:71], v[70:71], v[138:139]
    ds_write_b128 v7, v[68:71] offset:16128
    v_pk_add_f32 v[72:73], v[72:73], v[140:141]
    v_pk_add_f32 v[74:75], v[74:75], v[142:143]
    ds_write_b128 v7, v[72:75] offset:16192
    v_pk_add_f32 v[76:77], v[76:77], v[144:145]
    v_pk_add_f32 v[78:79], v[78:79], v[146:147]
    ds_write_b128 v7, v[76:79] offset:16256
    v_pk_add_f32 v[80:81], v[80:81], v[148:149]
    v_pk_add_f32 v[82:83], v[82:83], v[150:151]
    ds_write_b128 v7, v[80:83] offset:16320
    v_pk_add_f32 v[84:85], v[84:85], v[152:153]
    v_pk_add_f32 v[86:87], v[86:87], v[154:155]
    ds_write_b128 v7, v[84:87] offset:16384
    s_waitcnt lgkmcnt(0)
    s_branch K_fin
K_p2dft:
    s_waitcnt vmcnt(4)
    v_mfma_f32_16x16x32_bf16 v[8:11], v[196:199], v[88:91], 0
    v_mfma_f32_16x16x32_bf16 v[12:15], v[200:203], v[88:91], 0
    buffer_load_dwordx2 v[6:7], v1, s[20:23], s61 offen sc1
    v_mfma_f32_16x16x32_bf16 v[16:19], v[204:207], v[88:91], 0
    v_mfma_f32_16x16x32_bf16 v[20:23], v[208:211], v[88:91], 0
    v_mfma_f32_16x16x32_bf16 v[24:27], v[212:215], v[88:91], 0
    s_add_u32 s54, s42, 8192
    buffer_load_dwordx4 v[120:123], v2, s[20:23], s54 offen offset:0 sc1
    v_mfma_f32_16x16x32_bf16 v[44:47], v[212:215], v[92:95], 0
    v_mfma_f32_16x16x32_bf16 v[40:43], v[208:211], v[92:95], 0
    v_mfma_f32_16x16x32_bf16 v[36:39], v[204:207], v[92:95], 0
    v_mfma_f32_16x16x32_bf16 v[32:35], v[200:203], v[92:95], 0
    buffer_load_dwordx4 v[124:127], v2, s[20:23], s54 offen offset:1024 sc1
    v_mfma_f32_16x16x32_bf16 v[28:31], v[196:199], v[92:95], 0
    v_mfma_f32_16x16x32_bf16 v[48:51], v[196:199], v[96:99], 0
    v_mfma_f32_16x16x32_bf16 v[52:55], v[200:203], v[96:99], 0
    buffer_load_dwordx4 v[128:131], v2, s[20:23], s54 offen offset:2048 sc1
    v_mfma_f32_16x16x32_bf16 v[56:59], v[204:207], v[96:99], 0
    v_mfma_f32_16x16x32_bf16 v[60:63], v[208:211], v[96:99], 0
    v_mfma_f32_16x16x32_bf16 v[64:67], v[212:215], v[96:99], 0
    v_mfma_f32_16x16x32_bf16 v[84:87], v[212:215], v[100:103], 0
    buffer_load_dwordx4 v[132:135], v2, s[20:23], s54 offen offset:3072 sc1
    v_mfma_f32_16x16x32_bf16 v[80:83], v[208:211], v[100:103], 0
    v_mfma_f32_16x16x32_bf16 v[76:79], v[204:207], v[100:103], 0
    v_mfma_f32_16x16x32_bf16 v[72:75], v[200:203], v[100:103], 0
    v_mfma_f32_16x16x32_bf16 v[68:71], v[196:199], v[100:103], 0
    s_waitcnt vmcnt(5)
    v_mfma_f32_16x16x32_bf16 v[8:11], v[216:219], v[104:107], v[8:11]
    v_mfma_f32_16x16x32_bf16 v[12:15], v[220:223], v[104:107], v[12:15]
    s_add_u32 s54, s42, 12288
    buffer_load_dwordx4 v[88:91], v2, s[20:23], s54 offen offset:0 sc1
    v_mfma_f32_16x16x32_bf16 v[16:19], v[224:227], v[104:107], v[16:19]
    v_mfma_f32_16x16x32_bf16 v[20:23], v[228:231], v[104:107], v[20:23]
    v_mfma_f32_16x16x32_bf16 v[24:27], v[232:235], v[104:107], v[24:27]
    v_mfma_f32_16x16x32_bf16 v[44:47], v[232:235], v[108:111], v[44:47]
    buffer_load_dwordx4 v[92:95], v2, s[20:23], s54 offen offset:1024 sc1
    v_mfma_f32_16x16x32_bf16 v[40:43], v[228:231], v[108:111], v[40:43]
    v_mfma_f32_16x16x32_bf16 v[36:39], v[224:227], v[108:111], v[36:39]
    v_mfma_f32_16x16x32_bf16 v[32:35], v[220:223], v[108:111], v[32:35]
    v_mfma_f32_16x16x32_bf16 v[28:31], v[216:219], v[108:111], v[28:31]
    v_mfma_f32_16x16x32_bf16 v[48:51], v[216:219], v[112:115], v[48:51]
    buffer_load_dwordx4 v[96:99], v2, s[20:23], s54 offen offset:2048 sc1
    v_mfma_f32_16x16x32_bf16 v[52:55], v[220:223], v[112:115], v[52:55]
    v_mfma_f32_16x16x32_bf16 v[56:59], v[224:227], v[112:115], v[56:59]
    v_mfma_f32_16x16x32_bf16 v[60:63], v[228:231], v[112:115], v[60:63]
    v_mfma_f32_16x16x32_bf16 v[64:67], v[232:235], v[112:115], v[64:67]
    buffer_load_dwordx4 v[100:103], v2, s[20:23], s54 offen offset:3072 sc1
    v_mfma_f32_16x16x32_bf16 v[84:87], v[232:235], v[116:119], v[84:87]
    v_mfma_f32_16x16x32_bf16 v[80:83], v[228:231], v[116:119], v[80:83]
    v_mfma_f32_16x16x32_bf16 v[76:79], v[224:227], v[116:119], v[76:79]
    v_mfma_f32_16x16x32_bf16 v[72:75], v[220:223], v[116:119], v[72:75]
    v_mfma_f32_16x16x32_bf16 v[68:71], v[216:219], v[116:119], v[68:71]
    s_waitcnt vmcnt(4)
    s_waitcnt vmcnt(8)
    v_cmp_ne_u64 vcc, s[72:73], v[6:7]
    s_cbranch_vccnz K_slowT
K_backT:
    v_mfma_f32_16x16x32_bf16 v[8:11], v[236:239], v[120:123], v[8:11]
    v_mfma_f32_16x16x32_bf16 v[12:15], v[240:243], v[120:123], v[12:15]
    s_add_u32 s54, s42, 16384
    buffer_load_dwordx4 v[104:107], v2, s[20:23], s54 offen offset:0 sc1
    v_mfma_f32_16x16x32_bf16 v[16:19], v[244:247], v[120:123], v[16:19]
    v_mfma_f32_16x16x32_bf16 v[20:23], v[248:251], v[120:123], v[20:23]
    v_mfma_f32_16x16x32_bf16 v[24:27], v[252:255], v[120:123], v[24:27]
    buffer_load_dwordx4 v[108:111], v2, s[20:23], s54 offen offset:1024 sc1
    v_mfma_f32_16x16x32_bf16 v[44:47], v[252:255], v[124:127], v[44:47]
    v_mfma_f32_16x16x32_bf16 v[40:43], v[248:251], v[124:127], v[40:43]
    v_mfma_f32_16x16x32_bf16 v[36:39], v[244:247], v[124:127], v[36:39]
    v_mfma_f32_16x16x32_bf16 v[32:35], v[240:243], v[124:127], v[32:35]
    buffer_load_dwordx4 v[112:115], v2, s[20:23], s54 offen offset:2048 sc1
    v_mfma_f32_16x16x32_bf16 v[28:31], v[236:239], v[124:127], v[28:31]
    v_mfma_f32_16x16x32_bf16 v[48:51], v[236:239], v[128:131], v[48:51]
    v_mfma_f32_16x16x32_bf16 v[52:55], v[240:243], v[128:131], v[52:55]
    buffer_load_dwordx4 v[116:119], v2, s[20:23], s54 offen offset:3072 sc1
    v_mfma_f32_16x16x32_bf16 v[56:59], v[244:247], v[128:131], v[56:59]
    v_mfma_f32_16x16x32_bf16 v[60:63], v[248:251], v[128:131], v[60:63]
    v_mfma_f32_16x16x32_bf16 v[64:67], v[252:255], v[128:131], v[64:67]
    v_mfma_f32_16x16x32_bf16 v[84:87], v[252:255], v[132:135], v[84:87]
    s_add_u32 s39, s8, 0
    buffer_load_dwordx4 v[196:199], v5, s[20:23], s39 offen sc1
    v_mfma_f32_16x16x32_bf16 v[80:83], v[248:251], v[132:135], v[80:83]
    v_mfma_f32_16x16x32_bf16 v[76:79], v[244:247], v[132:135], v[76:79]
    v_mfma_f32_16x16x32_bf16 v[72:75], v[240:243], v[132:135], v[72:75]
    v_mfma_f32_16x16x32_bf16 v[68:71], v[236:239], v[132:135], v[68:71]
    s_waitcnt vmcnt(5)
    v_mfma_f32_16x16x32_bf16 v[8:11], v[136:139], v[88:91], v[8:11]
    v_mfma_f32_16x16x32_bf16 v[12:15], v[140:143], v[88:91], v[12:15]
    s_add_u32 s54, s42, 20480
    buffer_load_dwordx4 v[120:123], v2, s[20:23], s54 offen offset:0 sc1
    v_mfma_f32_16x16x32_bf16 v[16:19], v[144:147], v[88:91], v[16:19]
    v_mfma_f32_16x16x32_bf16 v[20:23], v[148:151], v[88:91], v[20:23]
    buffer_load_dwordx4 v[124:127], v2, s[20:23], s54 offen offset:1024 sc1
    v_mfma_f32_16x16x32_bf16 v[24:27], v[152:155], v[88:91], v[24:27]
    v_mfma_f32_16x16x32_bf16 v[44:47], v[152:155], v[92:95], v[44:47]
    v_mfma_f32_16x16x32_bf16 v[40:43], v[148:151], v[92:95], v[40:43]
    buffer_load_dwordx4 v[128:131], v2, s[20:23], s54 offen offset:2048 sc1
    v_mfma_f32_16x16x32_bf16 v[36:39], v[144:147], v[92:95], v[36:39]
    v_mfma_f32_16x16x32_bf16 v[32:35], v[140:143], v[92:95], v[32:35]
    buffer_load_dwordx4 v[132:135], v2, s[20:23], s54 offen offset:3072 sc1
    v_mfma_f32_16x16x32_bf16 v[28:31], v[136:139], v[92:95], v[28:31]
    v_mfma_f32_16x16x32_bf16 v[48:51], v[136:139], v[96:99], v[48:51]
    v_mfma_f32_16x16x32_bf16 v[52:55], v[140:143], v[96:99], v[52:55]
    s_add_u32 s39, s9, 0
    buffer_load_dwordx4 v[200:203], v5, s[20:23], s39 offen sc1
    v_mfma_f32_16x16x32_bf16 v[56:59], v[144:147], v[96:99], v[56:59]
    v_mfma_f32_16x16x32_bf16 v[60:63], v[148:151], v[96:99], v[60:63]
    s_add_u32 s39, s10, 0
    buffer_load_dwordx4 v[204:207], v5, s[20:23], s39 offen sc1
    v_mfma_f32_16x16x32_bf16 v[64:67], v[152:155], v[96:99], v[64:67]
    v_mfma_f32_16x16x32_bf16 v[84:87], v[152:155], v[100:103], v[84:87]
    v_mfma_f32_16x16x32_bf16 v[80:83], v[148:151], v[100:103], v[80:83]
    ds_read_b128 v[216:219], v4 offset:4096
    ds_read_b128 v[220:223], v4 offset:5120
    ds_read_b128 v[224:227], v4 offset:6144
    ds_read_b128 v[228:231], v4 offset:7168
    v_mfma_f32_16x16x32_bf16 v[76:79], v[144:147], v[100:103], v[76:79]
    v_mfma_f32_16x16x32_bf16 v[72:75], v[140:143], v[100:103], v[72:75]
    v_mfma_f32_16x16x32_bf16 v[68:71], v[136:139], v[100:103], v[68:71]
    s_waitcnt vmcnt(7)
    v_mfma_f32_16x16x32_bf16 v[8:11], v[156:159], v[104:107], v[8:11]
    v_mfma_f32_16x16x32_bf16 v[12:15], v[160:163], v[104:107], v[12:15]
    s_add_u32 s39, s11, 0
    buffer_load_dwordx4 v[208:211], v5, s[20:23], s39 offen sc1
    v_mfma_f32_16x16x32_bf16 v[16:19], v[164:167], v[104:107], v[16:19]
    v_mfma_f32_16x16x32_bf16 v[20:23], v[168:171], v[104:107], v[20:23]
    s_add_u32 s39, s12, 0
    buffer_load_dwordx4 v[212:215], v5, s[20:23], s39 offen sc1
    v_mfma_f32_16x16x32_bf16 v[24:27], v[172:175], v[104:107], v[24:27]
    v_mfma_f32_16x16x32_bf16 v[44:47], v[172:175], v[108:111], v[44:47]
    s_add_u32 s39, s8, 21504
    buffer_load_dwordx4 v[236:239], v5, s[20:23], s39 offen sc1
    v_mfma_f32_16x16x32_bf16 v[40:43], v[168:171], v[108:111], v[40:43]
    v_mfma_f32_16x16x32_bf16 v[36:39], v[164:167], v[108:111], v[36:39]
    s_add_u32 s39, s9, 21504
    buffer_load_dwordx4 v[240:243], v5, s[20:23], s39 offen sc1
    v_mfma_f32_16x16x32_bf16 v[32:35], v[160:163], v[108:111], v[32:35]
    v_mfma_f32_16x16x32_bf16 v[28:31], v[156:159], v[108:111], v[28:31]
    v_mfma_f32_16x16x32_bf16 v[48:51], v[156:159], v[112:115], v[48:51]
    s_add_u32 s39, s10, 21504
    buffer_load_dwordx4 v[244:247], v5, s[20:23], s39 offen sc1
    v_mfma_f32_16x16x32_bf16 v[52:55], v[160:163], v[112:115], v[52:55]
    v_mfma_f32_16x16x32_bf16 v[56:59], v[164:167], v[112:115], v[56:59]
    s_add_u32 s39, s11, 21504
    buffer_load_dwordx4 v[248:251], v5, s[20:23], s39 offen sc1
    v_mfma_f32_16x16x32_bf16 v[60:63], v[168:171], v[112:115], v[60:63]
    v_mfma_f32_16x16x32_bf16 v[64:67], v[172:175], v[112:115], v[64:67]
    s_add_u32 s39, s12, 21504
    buffer_load_dwordx4 v[252:255], v5, s[20:23], s39 offen sc1
    v_mfma_f32_16x16x32_bf16 v[84:87], v[172:175], v[116:119], v[84:87]
    v_mfma_f32_16x16x32_bf16 v[80:83], v[168:171], v[116:119], v[80:83]
    ds_read_b128 v[88:91], v4 offset:0
    ds_read_b128 v[92:95], v4 offset:1024
    ds_read_b128 v[96:99], v4 offset:2048
    ds_read_b128 v[100:103], v4 offset:3072
    v_mfma_f32_16x16x32_bf16 v[76:79], v[164:167], v[116:119], v[76:79]
    v_mfma_f32_16x16x32_bf16 v[72:75], v[160:163], v[116:119], v[72:75]
    v_mfma_f32_16x16x32_bf16 v[68:71], v[156:159], v[116:119], v[68:71]
    s_waitcnt vmcnt(9)
    v_mfma_f32_16x16x32_bf16 v[8:11], v[176:179], v[120:123], v[8:11]
    v_mfma_f32_16x16x32_bf16 v[12:15], v[180:183], v[120:123], v[12:15]
    s_mov_b32 s24, s4
    s_mov_b32 s25, s5
    s_mov_b32 s26, 2621440
    s_mov_b32 s27, 0x00020000
    s_mul_i32 s33, s41, 160
    v_add_u32 v136, 0, v0
    v_mul_u32_u24 v137, 6554, v136
    v_lshrrev_b32 v137, 16, v137
    v_mul_u32_u24 v138, 10, v137
    v_sub_u32 v138, v136, v138
    v_mul_u32_u24 v234, 336, v137
    v_lshl_add_u32 v234, v138, 5, v234
    v_mov_b32 v139, s40
    v_mov_b32 v140, s34
    v_cmp_gt_u32 vcc, 32, v137
    v_and_b32 v141, 31, v137
    s_nop 0
    v_cndmask_b32 v139, v140, v139, vcc
    v_lshl_add_u32 v139, v141, 6, v139
    v_mul_u32_u24 v139, 1280, v139
    v_lshl_add_u32 v139, v138, 4, v139
    v_add_u32 v232, s33, v139
    v_add_u32 v136, 512, v0
    v_mul_u32_u24 v137, 6554, v136
    v_lshrrev_b32 v137, 16, v137
    v_mul_u32_u24 v138, 10, v137
    v_sub_u32 v138, v136, v138
    v_mul_u32_u24 v235, 336, v137
    v_lshl_add_u32 v235, v138, 5, v235
    v_mov_b32 v139, s40
    v_mov_b32 v140, s34
    v_cmp_gt_u32 vcc, 32, v137
    v_and_b32 v141, 31, v137
    s_nop 0
    v_cndmask_b32 v139, v140, v139, vcc
    v_lshl_add_u32 v139, v141, 6, v139
    v_mul_u32_u24 v139, 1280, v139
    v_lshl_add_u32 v139, v138, 4, v139
    v_add_u32 v233, s33, v139
    v_cmp_gt_u32 vcc, 128, v0
    v_mov_b32 v140, 2146435072
    s_nop 0
    v_cndmask_b32 v233, v140, v233, vcc
    v_mfma_f32_16x16x32_bf16 v[16:19], v[184:187], v[120:123], v[16:19]
    v_mfma_f32_16x16x32_bf16 v[20:23], v[188:191], v[120:123], v[20:23]
    v_mfma_f32_16x16x32_bf16 v[24:27], v[192:195], v[120:123], v[24:27]
    v_mfma_f32_16x16x32_bf16 v[44:47], v[192:195], v[124:127], v[44:47]
    v_mfma_f32_16x16x32_bf16 v[40:43], v[188:191], v[124:127], v[40:43]
    v_mfma_f32_16x16x32_bf16 v[36:39], v[184:187], v[124:127], v[36:39]
    v_mfma_f32_16x16x32_bf16 v[32:35], v[180:183], v[124:127], v[32:35]
    v_mfma_f32_16x16x32_bf16 v[28:31], v[176:179], v[124:127], v[28:31]
    v_mfma_f32_16x16x32_bf16 v[48:51], v[176:179], v[128:131], v[48:51]
    s_and_b32 s39, s28, 3
    s_lshl_b32 s38, s39, 4
    s_add_u32 s38, s38, 143360
    v_mov_b32 v1, s38
    s_mul_i32 s39, s39, 21504
    v_add_u32 v3, s39, v2
    v_and_b32 v7, 15, v0
    v_mul_u32_u24 v7, 336, v7
    v_bfe_u32 v6, v0, 4, 2
    v_lshl_add_u32 v7, v6, 4, v7
    v_add_u32 v7, s39, v7
    v_mov_b32 v6, 1
    s_mov_b32 s80, s50
    s_mov_b32 s81, s51
    s_mov_b32 s82, 2621440
    s_mov_b32 s83, 0x00020000
    s_lshl_b32 s38, s28, 10
    s_add_u32 m0, s38, 133120
    s_cmp_ge_u32 s28, 2
    buffer_load_dwordx4 v232, s[24:27], 0 offen lds
    s_cbranch_scc1 K_nox2_2
    s_add_u32 m0, s38, 141312
    s_nop 0
    buffer_load_dwordx4 v233, s[24:27], 0 offen lds
K_nox2_2:
    v_mfma_f32_16x16x32_bf16 v[52:55], v[180:183], v[128:131], v[52:55]
    v_mfma_f32_16x16x32_bf16 v[56:59], v[184:187], v[128:131], v[56:59]
    v_mfma_f32_16x16x32_bf16 v[60:63], v[188:191], v[128:131], v[60:63]
    v_mfma_f32_16x16x32_bf16 v[64:67], v[192:195], v[128:131], v[64:67]
    v_mfma_f32_16x16x32_bf16 v[84:87], v[192:195], v[132:135], v[84:87]
    v_mfma_f32_16x16x32_bf16 v[80:83], v[188:191], v[132:135], v[80:83]
    v_mfma_f32_16x16x32_bf16 v[76:79], v[184:187], v[132:135], v[76:79]
    v_mfma_f32_16x16x32_bf16 v[72:75], v[180:183], v[132:135], v[72:75]
    v_mfma_f32_16x16x32_bf16 v[68:71], v[176:179], v[132:135], v[68:71]
    s_waitcnt vmcnt(1) lgkmcnt(0)
K_lpB0:
    ds_read_b32 v6, v1 offset:0
    s_waitcnt lgkmcnt(0)
    v_readfirstlane_b32 s39, v6
    s_nop 0
    s_cmp_eq_u32 s39, 0
    s_cbranch_scc1 K_lpB0
K_lqB0:
    s_nop 1
    ds_read_b128 v[136:139], v3 offset:0
    ds_read_b128 v[140:143], v3 offset:1024
    ds_read_b128 v[144:147], v3 offset:2048
    ds_read_b128 v[148:151], v3 offset:3072
    ds_read_b128 v[152:155], v3 offset:4096
    ds_read_b32 v6, v1 offset:4
    v_mfma_f32_16x16x32_bf16 v[8:11], v[196:199], v[88:91], v[8:11]
    v_mfma_f32_16x16x32_bf16 v[12:15], v[200:203], v[88:91], v[12:15]
    v_mfma_f32_16x16x32_bf16 v[16:19], v[204:207], v[88:91], v[16:19]
    v_mfma_f32_16x16x32_bf16 v[20:23], v[208:211], v[88:91], v[20:23]
    v_mfma_f32_16x16x32_bf16 v[24:27], v[212:215], v[88:91], v[24:27]
    v_mfma_f32_16x16x32_bf16 v[24:27], v[252:255], v[216:219], v[24:27]
    v_mfma_f32_16x16x32_bf16 v[20:23], v[248:251], v[216:219], v[20:23]
    v_mfma_f32_16x16x32_bf16 v[16:19], v[244:247], v[216:219], v[16:19]
    v_mfma_f32_16x16x32_bf16 v[12:15], v[240:243], v[216:219], v[12:15]
    v_mfma_f32_16x16x32_bf16 v[8:11], v[236:239], v[216:219], v[8:11]
    s_waitcnt lgkmcnt(0)
    v_readfirstlane_b32 s39, v6
    s_nop 0
    s_cmp_lg_u32 s39, 0
    s_cbranch_scc1 K_lqB1
K_lpB1:
    ds_read_b32 v6, v1 offset:4
    s_waitcnt lgkmcnt(0)
    v_readfirstlane_b32 s39, v6
    s_nop 0
    s_cmp_eq_u32 s39, 0
    s_cbranch_scc1 K_lpB1
K_lqB1:
    s_nop 1
    ds_read_b128 v[156:159], v3 offset:5376
    ds_read_b128 v[160:163], v3 offset:6400
    ds_read_b128 v[164:167], v3 offset:7424
    ds_read_b128 v[168:171], v3 offset:8448
    ds_read_b128 v[172:175], v3 offset:9472
    ds_read_b32 v6, v1 offset:8
    v_mfma_f32_16x16x32_bf16 v[28:31], v[196:199], v[92:95], v[28:31]
    v_add_f32 v8, v8, v136
    v_add_f32 v9, v9, v137
    v_mfma_f32_16x16x32_bf16 v[32:35], v[200:203], v[92:95], v[32:35]
    v_add_f32 v10, v10, v138
    v_add_f32 v11, v11, v139
    ds_write_b128 v7, v[8:11] offset:0
    v_mfma_f32_16x16x32_bf16 v[36:39], v[204:207], v[92:95], v[36:39]
    v_add_f32 v12, v12, v140
    v_add_f32 v13, v13, v141
    v_mfma_f32_16x16x32_bf16 v[40:43], v[208:211], v[92:95], v[40:43]
    v_add_f32 v14, v14, v142
    v_add_f32 v15, v15, v143
    ds_write_b128 v7, v[12:15] offset:64
    v_mfma_f32_16x16x32_bf16 v[44:47], v[212:215], v[92:95], v[44:47]
    v_add_f32 v16, v16, v144
    v_add_f32 v17, v17, v145
    v_mfma_f32_16x16x32_bf16 v[44:47], v[252:255], v[220:223], v[44:47]
    v_add_f32 v18, v18, v146
    v_add_f32 v19, v19, v147
    ds_write_b128 v7, v[16:19] offset:128
    v_mfma_f32_16x16x32_bf16 v[40:43], v[248:251], v[220:223], v[40:43]
    v_add_f32 v20, v20, v148
    v_add_f32 v21, v21, v149
    v_mfma_f32_16x16x32_bf16 v[36:39], v[244:247], v[220:223], v[36:39]
    v_add_f32 v22, v22, v150
    v_add_f32 v23, v23, v151
    ds_write_b128 v7, v[20:23] offset:192
    v_mfma_f32_16x16x32_bf16 v[32:35], v[240:243], v[220:223], v[32:35]
    v_add_f32 v24, v24, v152
    v_add_f32 v25, v25, v153
    v_mfma_f32_16x16x32_bf16 v[28:31], v[236:239], v[220:223], v[28:31]
    v_add_f32 v26, v26, v154
    v_add_f32 v27, v27, v155
    ds_write_b128 v7, v[24:27] offset:256
    s_waitcnt lgkmcnt(5)
    v_readfirstlane_b32 s39, v6
    s_nop 0
    s_cmp_lg_u32 s39, 0
    s_cbranch_scc1 K_lqB2
K_lpB2:
    ds_read_b32 v6, v1 offset:8
    s_waitcnt lgkmcnt(0)
    v_readfirstlane_b32 s39, v6
    s_nop 0
    s_cmp_eq_u32 s39, 0
    s_cbranch_scc1 K_lpB2
K_lqB2:
    s_nop 1
    ds_read_b128 v[136:139], v3 offset:10752
    ds_read_b128 v[140:143], v3 offset:11776
    ds_read_b128 v[144:147], v3 offset:12800
    ds_read_b128 v[148:151], v3 offset:13824
    ds_read_b128 v[152:155], v3 offset:14848
    ds_read_b32 v6, v1 offset:12
    v_mfma_f32_16x16x32_bf16 v[48:51], v[196:199], v[96:99], v[48:51]
    v_add_f32 v28, v28, v156
    v_add_f32 v29, v29, v157
    v_mfma_f32_16x16x32_bf16 v[52:55], v[200:203], v[96:99], v[52:55]
    v_add_f32 v30, v30, v158
    v_add_f32 v31, v31, v159
    ds_write_b128 v7, v[28:31] offset:5376
    v_mfma_f32_16x16x32_bf16 v[56:59], v[204:207], v[96:99], v[56:59]
    v_add_f32 v32, v32, v160
    v_add_f32 v33, v33, v161
    v_mfma_f32_16x16x32_bf16 v[60:63], v[208:211], v[96:99], v[60:63]
    v_add_f32 v34, v34, v162
    v_add_f32 v35, v35, v163
    ds_write_b128 v7, v[32:35] offset:5440
    v_mfma_f32_16x16x32_bf16 v[64:67], v[212:215], v[96:99], v[64:67]
    v_add_f32 v36, v36, v164
    v_add_f32 v37, v37, v165
    v_mfma_f32_16x16x32_bf16 v[64:67], v[252:255], v[224:227], v[64:67]
    v_add_f32 v38, v38, v166
    v_add_f32 v39, v39, v167
    ds_write_b128 v7, v[36:39] offset:5504
    v_mfma_f32_16x16x32_bf16 v[60:63], v[248:251], v[224:227], v[60:63]
    v_add_f32 v40, v40, v168
    v_add_f32 v41, v41, v169
    v_mfma_f32_16x16x32_bf16 v[56:59], v[244:247], v[224:227], v[56:59]
    v_add_f32 v42, v42, v170
    v_add_f32 v43, v43, v171
    ds_write_b128 v7, v[40:43] offset:5568
    v_mfma_f32_16x16x32_bf16 v[52:55], v[240:243], v[224:227], v[52:55]
    v_add_f32 v44, v44, v172
    v_add_f32 v45, v45, v173
    v_mfma_f32_16x16x32_bf16 v[48:51], v[236:239], v[224:227], v[48:51]
    v_add_f32 v46, v46, v174
    v_add_f32 v47, v47, v175
    ds_write_b128 v7, v[44:47] offset:5632
    s_waitcnt lgkmcnt(5)
    v_readfirstlane_b32 s39, v6
    s_nop 0
    s_cmp_lg_u32 s39, 0
    s_cbranch_scc1 K_lqB3
K_lpB3:
    ds_read_b32 v6, v1 offset:12
    s_waitcnt lgkmcnt(0)
    v_readfirstlane_b32 s39, v6
    s_nop 0
    s_cmp_eq_u32 s39, 0
    s_cbranch_scc1 K_lpB3
K_lqB3:
    s_nop 1
    ds_read_b128 v[156:159], v3 offset:16128
    ds_read_b128 v[160:163], v3 offset:17152
    ds_read_b128 v[164:167], v3 offset:18176
    ds_read_b128 v[168:171], v3 offset:19200
    ds_read_b128 v[172:175], v3 offset:20224
    v_mfma_f32_16x16x32_bf16 v[68:71], v[196:199], v[100:103], v[68:71]
    v_add_f32 v48, v48, v136
    v_add_f32 v49, v49, v137
    v_mfma_f32_16x16x32_bf16 v[72:75], v[200:203], v[100:103], v[72:75]
    v_add_f32 v50, v50, v138
    v_add_f32 v51, v51, v139
    ds_write_b128 v7, v[48:51] offset:10752
    v_mfma_f32_16x16x32_bf16 v[76:79], v[204:207], v[100:103], v[76:79]
    v_add_f32 v52, v52, v140
    v_add_f32 v53, v53, v141
    v_mfma_f32_16x16x32_bf16 v[80:83], v[208:211], v[100:103], v[80:83]
    v_add_f32 v54, v54, v142
    v_add_f32 v55, v55, v143
    ds_write_b128 v7, v[52:55] offset:10816
    v_mfma_f32_16x16x32_bf16 v[84:87], v[212:215], v[100:103], v[84:87]
    v_add_f32 v56, v56, v144
    v_add_f32 v57, v57, v145
    v_mfma_f32_16x16x32_bf16 v[84:87], v[252:255], v[228:231], v[84:87]
    v_add_f32 v58, v58, v146
    v_add_f32 v59, v59, v147
    ds_write_b128 v7, v[56:59] offset:10880
    v_mfma_f32_16x16x32_bf16 v[80:83], v[248:251], v[228:231], v[80:83]
    v_add_f32 v60, v60, v148
    v_add_f32 v61, v61, v149
    v_mfma_f32_16x16x32_bf16 v[76:79], v[244:247], v[228:231], v[76:79]
    v_add_f32 v62, v62, v150
    v_add_f32 v63, v63, v151
    ds_write_b128 v7, v[60:63] offset:10944
    v_mfma_f32_16x16x32_bf16 v[72:75], v[240:243], v[228:231], v[72:75]
    v_add_f32 v64, v64, v152
    v_add_f32 v65, v65, v153
    v_mfma_f32_16x16x32_bf16 v[68:71], v[236:239], v[228:231], v[68:71]
    v_add_f32 v66, v66, v154
    v_add_f32 v67, v67, v155
    ds_write_b128 v7, v[64:67] offset:11008
    s_nop 7
    s_waitcnt lgkmcnt(0)
    v_pk_add_f32 v[68:69], v[68:69], v[156:157]
    v_pk_add_f32 v[70:71], v[70:71], v[158:159]
    ds_write_b128 v7, v[68:71] offset:16128
    v_pk_add_f32 v[72:73], v[72:73], v[160:161]
    v_pk_add_f32 v[74:75], v[74:75], v[162:163]
    ds_write_b128 v7, v[72:75] offset:16192
    v_pk_add_f32 v[76:77], v[76:77], v[164:165]
    v_pk_add_f32 v[78:79], v[78:79], v[166:167]
    ds_write_b128 v7, v[76:79] offset:16256
    v_pk_add_f32 v[80:81], v[80:81], v[168:169]
    v_pk_add_f32 v[82:83], v[82:83], v[170:171]
    ds_write_b128 v7, v[80:83] offset:16320
    v_pk_add_f32 v[84:85], v[84:85], v[172:173]
    v_pk_add_f32 v[86:87], v[86:87], v[174:175]
    ds_write_b128 v7, v[84:87] offset:16384
    s_waitcnt lgkmcnt(0)
K_fin:
    v_lshlrev_b32 v4, 4, v0
    v_add_u32 v4, 133120, v4
    s_waitcnt vmcnt(0)
    s_barrier
    ds_read_b128 v[176:179], v234 offset:0
    ds_read_b128 v[180:183], v234 offset:16
    ds_read_b128 v[184:187], v234 offset:21504
    ds_read_b128 v[188:191], v234 offset:21520
    ds_read_b128 v[192:195], v234 offset:43008
    ds_read_b128 v[196:199], v234 offset:43024
    ds_read_b128 v[200:203], v234 offset:64512
    ds_read_b128 v[204:207], v234 offset:64528
    ds_read_b128 v[136:139], v4 offset:0
    s_cmp_ge_u32 s28, 2
    s_cbranch_scc1 K_f1
    ds_read_b128 v[8:11], v235 offset:0
    ds_read_b128 v[12:15], v235 offset:16
    ds_read_b128 v[16:19], v235 offset:21504
    ds_read_b128 v[20:23], v235 offset:21520
    ds_read_b128 v[24:27], v235 offset:43008
    ds_read_b128 v[28:31], v235 offset:43024
    ds_read_b128 v[32:35], v235 offset:64512
    ds_read_b128 v[36:39], v235 offset:64528
    ds_read_b128 v[140:143], v4 offset:8192
    s_waitcnt lgkmcnt(9)
    v_pk_add_f32 v[176:177], v[176:177], v[184:185]
    v_pk_add_f32 v[192:193], v[192:193], v[200:201]
    v_pk_add_f32 v[178:179], v[178:179], v[186:187]
    v_pk_add_f32 v[194:195], v[194:195], v[202:203]
    v_pk_add_f32 v[180:181], v[180:181], v[188:189]
    v_pk_add_f32 v[196:197], v[196:197], v[204:205]
    v_pk_add_f32 v[182:183], v[182:183], v[190:191]
    v_pk_add_f32 v[198:199], v[198:199], v[206:207]
    v_lshlrev_b32 v184, 16, v136
    v_and_b32 v185, 0xffff0000, v136
    v_lshlrev_b32 v186, 16, v137
    v_and_b32 v187, 0xffff0000, v137
    v_lshlrev_b32 v188, 16, v138
    v_and_b32 v189, 0xffff0000, v138
    v_lshlrev_b32 v190, 16, v139
    v_and_b32 v191, 0xffff0000, v139
    v_pk_add_f32 v[176:177], v[176:177], v[192:193]
    v_pk_add_f32 v[178:179], v[178:179], v[194:195]
    v_pk_add_f32 v[180:181], v[180:181], v[196:197]
    v_pk_add_f32 v[182:183], v[182:183], v[198:199]
    v_pk_add_f32 v[176:177], v[176:177], v[184:185]
    v_pk_add_f32 v[178:179], v[178:179], v[186:187]
    v_pk_add_f32 v[180:181], v[180:181], v[188:189]
    v_pk_add_f32 v[182:183], v[182:183], v[190:191]
    v_cvt_pk_bf16_f32 v208, v176, v177
    v_cvt_pk_bf16_f32 v209, v178, v179
    v_cvt_pk_bf16_f32 v210, v180, v181
    v_cvt_pk_bf16_f32 v211, v182, v183
    buffer_store_dwordx4 v[208:211], v232, s[80:83], 0 offen
    s_waitcnt lgkmcnt(0)
    v_pk_add_f32 v[8:9], v[8:9], v[16:17]
    v_pk_add_f32 v[24:25], v[24:25], v[32:33]
    v_pk_add_f32 v[10:11], v[10:11], v[18:19]
    v_pk_add_f32 v[26:27], v[26:27], v[34:35]
    v_pk_add_f32 v[12:13], v[12:13], v[20:21]
    v_pk_add_f32 v[28:29], v[28:29], v[36:37]
    v_pk_add_f32 v[14:15], v[14:15], v[22:23]
    v_pk_add_f32 v[30:31], v[30:31], v[38:39]
    v_lshlrev_b32 v16, 16, v140
    v_and_b32 v17, 0xffff0000, v140
    v_lshlrev_b32 v18, 16, v141
    v_and_b32 v19, 0xffff0000, v141
    v_lshlrev_b32 v20, 16, v142
    v_and_b32 v21, 0xffff0000, v142
    v_lshlrev_b32 v22, 16, v143
    v_and_b32 v23, 0xffff0000, v143
    v_pk_add_f32 v[8:9], v[8:9], v[24:25]
    v_pk_add_f32 v[10:11], v[10:11], v[26:27]
    v_pk_add_f32 v[12:13], v[12:13], v[28:29]
    v_pk_add_f32 v[14:15], v[14:15], v[30:31]
    v_pk_add_f32 v[8:9], v[8:9], v[16:17]
    v_pk_add_f32 v[10:11], v[10:11], v[18:19]
    v_pk_add_f32 v[12:13], v[12:13], v[20:21]
    v_pk_add_f32 v[14:15], v[14:15], v[22:23]
    v_cvt_pk_bf16_f32 v40, v8, v9
    v_cvt_pk_bf16_f32 v41, v10, v11
    v_cvt_pk_bf16_f32 v42, v12, v13
    v_cvt_pk_bf16_f32 v43, v14, v15
    buffer_store_dwordx4 v[40:43], v233, s[80:83], 0 offen
    s_branch K_done
K_f1:
    s_waitcnt lgkmcnt(0)
    v_pk_add_f32 v[176:177], v[176:177], v[184:185]
    v_pk_add_f32 v[192:193], v[192:193], v[200:201]
    v_pk_add_f32 v[178:179], v[178:179], v[186:187]
    v_pk_add_f32 v[194:195], v[194:195], v[202:203]
    v_pk_add_f32 v[180:181], v[180:181], v[188:189]
    v_pk_add_f32 v[196:197], v[196:197], v[204:205]
    v_pk_add_f32 v[182:183], v[182:183], v[190:191]
    v_pk_add_f32 v[198:199], v[198:199], v[206:207]
    v_lshlrev_b32 v184, 16, v136
    v_and_b32 v185, 0xffff0000, v136
    v_lshlrev_b32 v186, 16, v137
    v_and_b32 v187, 0xffff0000, v137
    v_lshlrev_b32 v188, 16, v138
    v_and_b32 v189, 0xffff0000, v138
    v_lshlrev_b32 v190, 16, v139
    v_and_b32 v191, 0xffff0000, v139
    v_pk_add_f32 v[176:177], v[176:177], v[192:193]
    v_pk_add_f32 v[178:179], v[178:179], v[194:195]
    v_pk_add_f32 v[180:181], v[180:181], v[196:197]
    v_pk_add_f32 v[182:183], v[182:183], v[198:199]
    v_pk_add_f32 v[176:177], v[176:177], v[184:185]
    v_pk_add_f32 v[178:179], v[178:179], v[186:187]
    v_pk_add_f32 v[180:181], v[180:181], v[188:189]
    v_pk_add_f32 v[182:183], v[182:183], v[190:191]
    v_cvt_pk_bf16_f32 v208, v176, v177
    v_cvt_pk_bf16_f32 v209, v178, v179
    v_cvt_pk_bf16_f32 v210, v180, v181
    v_cvt_pk_bf16_f32 v211, v182, v183
    buffer_store_dwordx4 v[208:211], v232, s[80:83], 0 offen
K_done:
    s_endpgm
K_slowT:
    s_mov_b32 s63, 0
K_slowT_l:
    buffer_load_dwordx2 v[6:7], v1, s[20:23], s61 offen sc1
    s_add_u32 s63, s63, 1
    s_waitcnt vmcnt(0)
    v_cmp_ne_u64 vcc, s[72:73], v[6:7]
    s_cmp_gt_u32 s63, 131072
    s_cbranch_scc1 K_backT
    s_cbranch_vccnz K_slowT_l
    s_branch K_backT
K_end:
    s_endpgm
.section .rodata,"a"
.p2align 6
.amdhsa_kernel parallel_sum__spectral_fnet__geglu_ffn__prompt_kernel
  .amdhsa_next_free_vgpr 256
  .amdhsa_next_free_sgpr 102
  .amdhsa_accum_offset 256
  .amdhsa_group_segment_fixed_size 0
  .amdhsa_kernarg_size 96
  .amdhsa_user_sgpr_count 2
  .amdhsa_user_sgpr_kernarg_segment_ptr 1
  .amdhsa_system_sgpr_workgroup_id_x 1
  .amdhsa_float_denorm_mode_32 3
  .amdhsa_float_denorm_mode_16_64 3
.end_amdhsa_kernel
```
